```python
import torch

def _softmax(x, axis=-1):
    return torch.softmax(x, dim=axis)
def _gelu(x):
    return torch.nn.functional.gelu(x, approximate="tanh")
def _silu(x):
    return torch.nn.functional.silu(x)
def _sigmoid(x):
    return torch.sigmoid(x)
def _layernorm(x, axis=-1, eps=1e-5):
    m = x.mean(dim=axis, keepdim=True)
    v = x.var(dim=axis, keepdim=True, unbiased=False)
    return (x - m) / torch.sqrt(v + eps)
def _scatter_add(tgt, idx, src, axis=0):
    return tgt.clone().index_add_(axis, idx, src)
def _segment_sum(src, seg, n):
    out = torch.zeros((n,) + src.shape[1:], dtype=src.dtype)
    return out.index_add_(0, seg, src)
def _pad(x, pw):
    flat = tuple(v for pair in reversed(pw) for v in pair)
    return torch.nn.functional.pad(x, flat)

kernel_name = 'gated_mix__linear_kernel_hedgehog__softmax_full_mha__prompt'

def setup_inputs():

    _w = (lambda a: (lambda t: t.to(torch.bfloat16) if t.is_floating_point() else t)(torch.as_tensor(a)))
    def _A_setup():
        B, S, D, H = 1, 2048, 1024, 32
        Dh = D // H
        return {
            "x": _w((lambda *s: torch.randn(*s, dtype=torch.bfloat16) * 0.05)(B, S, D)),
            "wqkv": _w((lambda *s: torch.randn(*s, dtype=torch.bfloat16) * 3.2)(D, 3 * D)),
            "w_phi": _w((lambda *s: torch.randn(*s, dtype=torch.bfloat16) * 3.2)(H, Dh, Dh) * (Dh ** -0.5)),
            "wo": _w((lambda *s: torch.randn(*s, dtype=torch.bfloat16) * 1.6)(D, D)),
        }
    _A_in = _A_setup()

    def _B_setup():
        B, S, D = 1, 2048, 1024
        return {
            "x": _w((lambda *s: torch.randn(*s, dtype=torch.bfloat16) * 0.05)(B, S, D)),
            "wqkv": _w((lambda *s: torch.randn(*s, dtype=torch.bfloat16) * 3.2)(D, 3 * D)),
            "wo": _w((lambda *s: torch.randn(*s, dtype=torch.bfloat16) * 0.1)(D, D)),
        }
    _B_in = _B_setup()

    return {
        "A_x": _A_in["x"],
        "A_wqkv": _A_in["wqkv"],
        "A_w_phi": _A_in["w_phi"],
        "A_wo": _A_in["wo"],
        "B_x": _B_in["x"],
        "B_wqkv": _B_in["wqkv"],
        "B_wo": _B_in["wo"],
        "gate_w": _w((lambda *s: torch.randn(*s, dtype=torch.bfloat16) * 0.4)(1024) * 16.0),
    }

def reference(A_x, A_wqkv, A_w_phi, A_wo, B_x, B_wqkv, B_wo, gate_w):
    def _A_ref(x, wqkv, w_phi, wo):
        B, S, D = x.shape
        H = 32; Dh = D // H
        qkv = (lambda x, *d: x.permute(*d))((x @ wqkv).reshape(B, S, 3, H, Dh), 2, 0, 3, 1, 4)
        q, k, v = qkv[0], qkv[1], qkv[2]
        pq = torch.einsum("bhsd,hdf->bhsf", q, w_phi)
        pk = torch.einsum("bhsd,hdf->bhsf", k, w_phi)
        phi_q = torch.concatenate([_softmax(pq, axis=-1), _softmax(-pq, axis=-1)], axis=-1)
        phi_k = torch.concatenate([_softmax(pk, axis=-1), _softmax(-pk, axis=-1)], axis=-1)
        kv = torch.einsum("bhsf,bhsd->bhfd", phi_k, v)
        z  = torch.einsum("bhsf->bhf", phi_k)
        num = torch.einsum("bhqf,bhfd->bhqd", phi_q, kv)
        den = torch.einsum("bhqf,bhf->bhq", phi_q, z)[..., None] + 1e-6
        o = num / den
        return (lambda x, *d: x.permute(*d))(o, 0, 2, 1, 3).reshape(B, S, D) @ wo

    def _B_ref(x, wqkv, wo):
        B, S, D = x.shape
        H = 32; Dh = D // H
        qkv = (lambda x, *d: x.permute(*d))((x @ wqkv).reshape(B, S, 3, H, Dh), 2, 0, 3, 1, 4)
        q, k, v = qkv[0], qkv[1], qkv[2]
        scale = Dh ** -0.5
        scores = torch.einsum("bhqd,bhkd->bhqk", q, k) * scale
        p = _softmax(scores, axis=-1)
        o = torch.einsum("bhqk,bhkd->bhqd", p, v)
        return (lambda x, *d: x.permute(*d))(o, 0, 2, 1, 3).reshape(B, S, D) @ wo

    x = A_x
    g = _sigmoid((x * gate_w).sum(-1, keepdims=True))
    a = _A_ref(x, A_wqkv, A_w_phi, A_wo)
    b = _B_ref(x, B_wqkv, B_wo)
    return g * a + (1 - g) * b
```

```asm
; @launch grid=(256,1,1) block=(512,1,1) lds=163840
.amdgcn_target "amdgcn-amd-amdhsa--gfx950"
.text
.p2align 12
.globl gated_mix__linear_kernel_hedgehog__softmax_full_mha__prompt_kernel
.p2align 8
.type gated_mix__linear_kernel_hedgehog__softmax_full_mha__prompt_kernel,@function
gated_mix__linear_kernel_hedgehog__softmax_full_mha__prompt_kernel:
    s_cmp_ge_u32 s2, 256
    s_cbranch_scc1 KF_END
    s_load_dwordx2 s[4:5], s[0:1], 0
    s_load_dwordx2 s[6:7], s[0:1], 8
    s_load_dwordx2 s[8:9], s[0:1], 40
    s_load_dwordx2 s[10:11], s[0:1], 16
    s_load_dwordx2 s[12:13], s[0:1], 56
    s_load_dwordx2 s[14:15], s[0:1], 80
    s_load_dwordx2 s[86:87], s[0:1], 72
    v_lshrrev_b32 v1, 6, v0
    v_and_b32 v0, 63, v0
    v_readfirstlane_b32 s40, v1
    s_and_b32 s45, s2, 7
    s_lshr_b32 s46, s2, 3
    s_and_b32 s41, s45, 1
    s_lshl_b32 s41, s41, 2
    s_lshr_b32 s47, s46, 3
    s_add_u32 s41, s41, s47
    s_lshr_b32 s42, s45, 1
    s_lshl_b32 s42, s42, 3
    s_and_b32 s47, s46, 7
    s_add_u32 s42, s42, s47
    s_cmp_lt_u32 s40, 4
    s_cbranch_scc1 K1_CONS
K1_LOADER:
    s_setprio 3
    s_sub_u32 s50, s40, 4
    s_lshr_b32 s44, s50, 1
    s_lshr_b32 s47, s45, 0
    s_mul_i32 s47, s47, 0
    s_and_b32 s51, s45, 1
    s_mul_i32 s51, s51, 0
    s_add_u32 s47, s47, s51
    s_and_b32 s51, s50, 1
    s_lshl_b32 s51, s51, 1
    s_add_u32 s51, s51, s47
    v_mul_u32_u24 v20, 43, v0
    v_lshrrev_b32 v20, 9, v20
    v_mul_u32_u24 v21, 12, v20
    v_sub_u32 v21, v0, v21
    v_add_u32 v20, s51, v20
    v_and_b32 v20, 31, v20
    v_mul_u32_u24 v20, 196608, v20
    s_and_b32 s51, s42, 1
    s_lshl_b32 s51, s51, 2
    s_and_b32 s52, s41, 3
    s_add_u32 s51, s51, s52
    s_lshl_b32 s51, s51, 2
    v_and_b32 v22, 3, v21
    v_add_u32 v22, s51, v22
    v_mul_u32_u24 v22, 6144, v22
    v_lshrrev_b32 v21, 2, v21
    v_lshl_add_u32 v22, v21, 11, v22
    s_lshr_b32 s51, s42, 1
    s_lshl_b32 s51, s51, 7
    v_add3_u32 v20, v20, v22, s51
    v_mov_b32 v23, 0x7ffffff0
    v_cmp_gt_u32 vcc, 24, v0
    s_lshl_b32 s51, s41, 8
    s_and_b32 s52, s42, 7
    s_lshl_b32 s52, s52, 5
    v_cndmask_b32 v20, v23, v20, vcc
    s_add_u32 s51, s51, s52
    s_lshl_b32 s52, s50, 3
    s_add_u32 s51, s51, s52
    v_and_b32 v21, 7, v0
    v_add_u32 v21, s51, v21
    v_lshlrev_b32 v21, 11, v21
    v_lshrrev_b32 v22, 3, v0
    s_lshr_b32 s47, s47, 1
    v_add_u32 v22, s47, v22
    v_and_b32 v22, 15, v22
    v_lshl_add_u32 v21, v22, 7, v21
    v_cmp_gt_u32 vcc, 16, v0
    s_nop 1
    v_cndmask_b32 v21, v23, v21, vcc
    v_lshrrev_b32 v1, 3, v0
    v_lshrrev_b32 v2, 4, v0
    v_and_b32 v3, 7, v0
    v_xor_b32 v3, v3, v2
    v_lshlrev_b32 v3, 4, v3
    v_lshl_add_u32 v4, v1, 11, v3
    s_lshl_b32 s47, s41, 8
    s_lshl_b32 s51, s50, 6
    s_add_u32 s47, s47, s51
    s_lshl_b32 s47, s47, 11
    v_add_u32 v4, s47, v4
    v_xor_b32 v5, 64, v4
    v_add_u32 v5, 16384, v5
    v_add_u32 v6, 32768, v4
    v_add_u32 v7, 32768, v5
    v_add_u32 v12, 65536, v4
    v_add_u32 v13, 65536, v5
    v_add_u32 v14, 98304, v4
    v_add_u32 v15, 98304, v5
    s_waitcnt lgkmcnt(0)
    s_cmp_eq_u32 s44, 0
    s_cselect_b32 s28, s6, s8
    s_cselect_b32 s29, s7, s9
    s_mov_b32 s30, 6291456
    s_mov_b32 s31, 0x00020000
    buffer_load_dword v24, v20, s[28:31], 0 offen
    s_mov_b32 s16, s4
    s_mov_b32 s17, s5
    s_mov_b32 s18, 4194304
    s_mov_b32 s19, 0x00020000
    buffer_load_dword v25, v21, s[16:19], 0 offen
    s_mov_b32 s20, s6
    s_mov_b32 s21, s7
    s_mov_b32 s22, 6291456
    s_mov_b32 s23, 0x00020000
    s_mov_b32 s24, s8
    s_mov_b32 s25, s9
    s_mov_b32 s26, 6291456
    s_mov_b32 s27, 0x00020000
    s_mov_b32 s36, s10
    s_mov_b32 s37, s11
    s_mov_b32 s38, 65536
    s_mov_b32 s39, 0x00020000
    s_mov_b32 s32, s14
    s_mov_b32 s33, s15
    s_mov_b32 s34, 33554432
    s_mov_b32 s35, 0x00020000
    v_lshrrev_b32 v1, 2, v0
    s_and_b32 s47, s50, 1
    s_lshl_b32 s47, s47, 4
    v_add_u32 v1, s47, v1
    v_mul_u32_u24 v1, 6144, v1
    v_and_b32 v3, 3, v0
    v_lshrrev_b32 v2, 4, v0
    v_and_b32 v2, 2, v2
    v_xor_b32 v3, v2, v3
    v_lshl_add_u32 v1, v3, 4, v1
    s_lshl_b32 s47, s42, 6
    s_lshl_b32 s51, s44, 11
    s_add_u32 s52, s47, s51
    v_add_u32 v9, s52, v1
    s_sub_u32 s52, 2048, s51
    s_add_u32 s52, s52, s47
    v_add_u32 v8, s52, v1
    s_add_u32 s52, s47, 4096
    v_add_u32 v10, s52, v1
    v_lshlrev_b32 v11, 4, v0
    s_and_b32 s51, s50, 1
    s_lshl_b32 s51, s51, 10
    s_lshl_b32 s47, s42, 11
    s_add_u32 s47, s47, s51
    s_add_u32 m0, s51, 159744
    s_lshl_b32 s55, s50, 13
    buffer_load_dwordx4 v11, s[36:39], s47 offen lds
    s_lshl_b32 s51, s50, 10
    s_add_u32 s56, s51, 98304
    s_lshr_b32 s47, s45, 0
    s_mul_i32 s47, s47, 0
    s_and_b32 s51, s45, 1
    s_mul_i32 s51, s51, 0
    s_add_u32 s47, s47, s51
    s_and_b32 s47, s47, 31
    s_lshl_b32 s58, s47, 6
    s_mul_i32 s59, s47, 196608
    s_mov_b32 s60, 0
    s_mov_b32 s61, s55
    s_mov_b32 s62, s56
    s_add_u32 s55, s55, 98304
    s_add_u32 s56, s56, 61440
    s_mov_b32 s92, s4
    s_mov_b32 s93, s5
    s_mov_b32 s94, 0
    s_mov_b32 s95, 0x00020000
    s_mov_b32 s64, 0
    v_mov_b32 v26, 0
    s_setprio 0
K1_LLOOP:
    s_add_u32 m0, s62, 0
    s_nop 0
    buffer_load_dwordx4 v8, s[20:23], s59 offen lds
    s_add_u32 m0, s62, 4096
    s_nop 0
    buffer_load_dwordx4 v9, s[24:27], s59 offen lds
    s_add_u32 m0, s62, 8192
    s_nop 0
    buffer_load_dwordx4 v10, s[28:31], s59 offen lds
    s_add_u32 s59, s59, 196608
    s_cmp_eq_u32 s59, 6291456
    s_cselect_b32 s59, 0, s59
    s_add_u32 s62, s62, 12288
    s_cmp_eq_u32 s62, s56
    s_cselect_b32 s47, 61440, 0
    s_sub_u32 s62, s62, s47
    s_add_u32 m0, s61, 0
    s_nop 0
    buffer_load_dwordx4 v4, s[16:19], s58 offen lds
    s_add_u32 m0, s61, 1024
    s_nop 0
    buffer_load_dwordx4 v5, s[16:19], s58 offen lds
    s_add_u32 m0, s61, 2048
    s_nop 0
    buffer_load_dwordx4 v6, s[16:19], s58 offen lds
    s_cmp_lt_u32 s60, 4
    s_cbranch_scc1 K1_LS1
    s_waitcnt vmcnt(10)
    s_barrier
K1_LS1:
    s_add_u32 m0, s61, 3072
    s_nop 0
    buffer_load_dwordx4 v7, s[16:19], s58 offen lds
    s_add_u32 m0, s61, 4096
    s_nop 0
    buffer_load_dwordx4 v12, s[16:19], s58 offen lds
    s_add_u32 m0, s61, 5120
    s_nop 0
    buffer_load_dwordx4 v13, s[16:19], s58 offen lds
    s_add_u32 m0, s61, 6144
    s_nop 0
    buffer_load_dwordx4 v14, s[16:19], s58 offen lds
    s_add_u32 m0, s61, 7168
    s_nop 0
    buffer_load_dwordx4 v15, s[16:19], s58 offen lds
    s_add_u32 s58, s58, 128
    s_and_b32 s58, s58, 2047
    s_add_u32 s61, s61, 32768
    s_cmp_eq_u32 s61, s55
    s_cselect_b32 s47, 98304, 0
    s_sub_u32 s61, s61, s47
    s_add_u32 m0, s62, 0
    s_nop 0
    buffer_load_dwordx4 v8, s[20:23], s59 offen lds
    s_add_u32 m0, s62, 4096
    s_nop 0
    buffer_load_dwordx4 v9, s[24:27], s59 offen lds
    s_add_u32 m0, s62, 8192
    s_nop 0
    buffer_load_dwordx4 v10, s[28:31], s59 offen lds
    s_add_u32 s59, s59, 196608
    s_cmp_eq_u32 s59, 6291456
    s_cselect_b32 s59, 0, s59
    s_add_u32 s62, s62, 12288
    s_cmp_eq_u32 s62, s56
    s_cselect_b32 s47, 61440, 0
    s_sub_u32 s62, s62, s47
    s_cmp_lg_u32 s60, 0
    s_cbranch_scc1 K1_PFS
    s_and_b32 s47, s42, 1
    s_lshl_b32 s47, s47, 2
    s_and_b32 s38, s41, 3
    s_add_u32 s47, s47, s38
    s_lshl_b32 s47, s47, 2
    v_bfe_u32 v27, v0, 2, 1
    v_lshlrev_b32 v27, 5, v27
    v_and_b32 v29, 3, v0
    v_add3_u32 v26, v29, v27, s47
    v_mul_u32_u24 v26, 6144, v26
    v_lshrrev_b32 v28, 3, v0
    v_lshl_add_u32 v26, v28, 11, v26
    s_lshr_b32 s47, s42, 1
    s_lshl_b32 s47, s47, 7
    v_add_u32 v26, s47, v26
    s_and_b32 s66, s42, 7
    s_lshl_b32 s47, s66, 2
    s_add_u32 s47, s47, s38
    s_lshl_b32 s47, s47, 2
    v_add_u32 v29, s47, v29
    v_lshrrev_b32 v28, 5, v29
    v_and_b32 v29, 31, v29
    v_add_u32 v29, v29, v27
    v_mul_u32_u24 v29, 6144, v29
    v_lshl_add_u32 v29, v28, 11, v29
    s_lshr_b32 s47, s42, 1
    s_or_b32 s47, s47, 3
    s_lshl_b32 s47, s47, 7
    v_add_u32 v29, s47, v29
    v_cmp_lt_u32 vcc, 23, v0
    s_nop 1
    v_cndmask_b32 v26, v26, v29, vcc
    s_cmp_lt_u32 s66, 6
    s_cselect_b32 s63, 32, 0
    s_mul_i32 s47, s66, 43
    s_cmp_lt_u32 s66, 5
    s_cselect_b32 s38, 43, 41
    s_cmp_lt_u32 s66, 6
    s_cselect_b32 s66, s38, 0
    s_cmp_eq_u32 s50, 3
    s_cselect_b32 s66, 0, s66
    s_lshl_b32 s38, s41, 8
    s_add_u32 s47, s47, s38
    v_add_u32 v28, s47, v0
    v_lshlrev_b32 v28, 11, v28
    v_bfe_u32 v27, v0, 1, 1
    s_and_b32 s38, s45, 1
    v_xor_b32 v27, s38, v27
    v_and_b32 v29, 3, v0
    s_lshr_b32 s38, s45, 1
    v_xor_b32 v29, s38, v29
    s_cmp_ge_u32 s50, 2
    s_cselect_b64 vcc, -1, 0
    s_cselect_b32 s47, s66, s63
    s_mov_b32 s38, 589824
    s_cselect_b32 s38, 192, s38
    v_cndmask_b32 v26, v26, v28, vcc
    v_cndmask_b32 v27, v27, v29, vcc
    v_cmp_eq_u32 vcc, 0, v27
    v_mov_b32 v28, s38
    s_nop 0
    v_cndmask_b32 v28, 0, v28, vcc
    v_add_u32 v26, v26, v28
    v_cmp_gt_u32 vcc, s47, v0
    v_mov_b32 v28, 0x7ffffff0
    s_nop 0
    v_cndmask_b32 v26, v28, v26, vcc
    s_cmp_eq_u32 s50, 0
    s_cselect_b32 s92, s6, s8
    s_cselect_b32 s93, s7, s9
    s_cmp_ge_u32 s50, 2
    s_cselect_b32 s92, s4, s92
    s_cselect_b32 s93, s5, s93
    s_mov_b32 s94, 6291456
    s_cselect_b32 s94, 4194304, s94
    s_mov_b32 s95, 0x00020000
    s_mov_b32 s67, s94
    s_cmp_ge_u32 s50, 2
    s_mov_b32 s64, 786432
    s_cselect_b32 s64, 256, s64
    s_mov_b32 s65, 393216
    s_cselect_b32 s65, 128, s65
K1_PFS:
    s_cmp_le_u32 s60, 26
    s_cselect_b32 s94, s67, 0
    buffer_load_dword v31, v26, s[92:95], s64 offen
    s_add_u32 s64, s64, s65
    s_cmp_lt_u32 s60, 2
    s_cbranch_scc1 K1_LS2
    s_waitcnt vmcnt(16)
    s_barrier
K1_LS2:
    s_add_u32 s60, s60, 2
    s_cmp_lt_u32 s60, 32
    s_cbranch_scc1 K1_LLOOP
    s_branch K1_LPOST
K1_CONS:
    s_waitcnt lgkmcnt(0)
    s_mov_b32 s32, s14
    s_mov_b32 s33, s15
    s_mov_b32 s34, 33554432
    s_mov_b32 s35, 0x00020000
    s_and_b32 s47, s42, 1
    s_lshl_b32 s47, s47, 2
    s_and_b32 s38, s41, 3
    s_add_u32 s47, s47, s38
    s_lshl_b32 s47, s47, 2
    v_bfe_u32 v4, v0, 2, 1
    v_lshlrev_b32 v4, 5, v4
    v_and_b32 v6, 3, v0
    v_add3_u32 v252, v6, v4, s47
    v_mul_u32_u24 v252, 6144, v252
    v_lshrrev_b32 v5, 3, v0
    v_lshl_add_u32 v252, v5, 11, v252
    s_lshr_b32 s47, s42, 1
    s_lshl_b32 s47, s47, 7
    v_add_u32 v252, s47, v252
    s_and_b32 s62, s42, 7
    s_lshl_b32 s47, s62, 2
    s_add_u32 s47, s47, s38
    s_lshl_b32 s47, s47, 2
    v_add_u32 v6, s47, v6
    v_lshrrev_b32 v5, 5, v6
    v_and_b32 v6, 31, v6
    v_add_u32 v6, v6, v4
    v_mul_u32_u24 v6, 6144, v6
    v_lshl_add_u32 v6, v5, 11, v6
    s_lshr_b32 s47, s42, 1
    s_or_b32 s47, s47, 3
    s_lshl_b32 s47, s47, 7
    v_add_u32 v6, s47, v6
    v_cmp_lt_u32 vcc, 23, v0
    s_nop 1
    v_cndmask_b32 v252, v252, v6, vcc
    s_cmp_lt_u32 s62, 6
    s_cselect_b32 s63, 32, 0
    s_mul_i32 s47, s62, 43
    s_cmp_lt_u32 s62, 5
    s_cselect_b32 s38, 43, 41
    s_cmp_lt_u32 s62, 6
    s_cselect_b32 s62, s38, 0
    s_cmp_eq_u32 s40, 3
    s_cselect_b32 s62, 0, s62
    s_lshl_b32 s38, s41, 8
    s_add_u32 s47, s47, s38
    v_add_u32 v5, s47, v0
    v_lshlrev_b32 v5, 11, v5
    v_bfe_u32 v4, v0, 1, 1
    s_and_b32 s38, s45, 1
    v_xor_b32 v4, s38, v4
    v_and_b32 v6, 3, v0
    s_lshr_b32 s38, s45, 1
    v_xor_b32 v6, s38, v6
    s_cmp_ge_u32 s40, 2
    s_cselect_b64 vcc, -1, 0
    s_cselect_b32 s47, s62, s63
    s_mov_b32 s38, 589824
    s_cselect_b32 s38, 192, s38
    v_cndmask_b32 v252, v252, v5, vcc
    v_cndmask_b32 v4, v4, v6, vcc
    v_cmp_eq_u32 vcc, 0, v4
    v_cmp_gt_u32 s[62:63], s47, v0
    v_mov_b32 v5, 0x7ffffff0
    s_and_b64 vcc, vcc, s[62:63]
    v_cndmask_b32 v254, v5, v252, vcc
    v_cndmask_b32 v252, v5, v252, s[62:63]
    s_cmp_eq_u32 s40, 0
    s_cselect_b32 s92, s6, s8
    s_cselect_b32 s93, s7, s9
    s_cmp_ge_u32 s40, 2
    s_cselect_b32 s92, s4, s92
    s_cselect_b32 s93, s5, s93
    s_mov_b32 s94, 6291456
    s_cselect_b32 s94, 4194304, s94
    s_mov_b32 s95, 0x00020000
    s_cmp_ge_u32 s40, 2
    s_mov_b32 s59, 393216
    s_cselect_b32 s59, 128, s59
    s_mov_b32 s55, 0
    s_cmp_ge_u32 s40, 2
    s_mov_b32 s55, 786432
    s_cselect_b32 s55, 256, s55
    s_lshl_b32 s70, s42, 18
    s_add_u32 s70, s70, 4194304
    s_lshl_b32 s47, s41, 1
    s_add_u32 s47, s47, 3
    s_and_b32 s47, s47, 15
    s_lshl_b32 s47, s47, 14
    s_lshl_b32 s38, s40, 11
    s_add_u32 s71, s47, s38
    s_add_u32 s72, s38, 49152
    s_lshl_b32 s47, s41, 3
    s_add_u32 s47, s47, s40
    s_lshl_b32 s47, s47, 5
    s_add_u32 s47, s47, s42
    s_lshl_b32 s73, s47, 11
    s_add_u32 s73, s73, 29360128
    s_lshr_b32 s39, s40, 1
    s_and_b32 s39, s39, 1
    s_lshl_b32 s47, s41, 3
    s_lshl_b32 s38, s39, 2
    s_add_u32 s47, s47, s38
    s_lshl_b32 s47, s47, 5
    s_add_u32 s47, s47, s42
    s_lshl_b32 s74, s47, 11
    s_add_u32 s74, s74, 25165824
    s_lshl_b32 s75, s42, 16
    s_lshl_b32 s47, s40, 10
    s_add_u32 s75, s75, s47
    s_add_u32 s75, s75, 20971520
    s_lshl_b32 s47, s41, 13
    s_add_u32 s79, s75, s47
    s_lshl_b32 s76, s42, 11
    s_add_u32 s76, s76, 23068672
    s_lshl_b32 s47, s41, 8
    s_add_u32 s89, s76, s47
    s_lshl_b32 s77, s42, 8
    s_add_u32 s77, s77, 24121344
    s_lshl_b32 s47, s41, 5
    s_add_u32 s68, s77, s47
    s_lshl_b32 s47, s40, 2
    s_add_u32 s68, s68, s47
    s_lshl_b32 s78, s42, 6
    s_add_u32 s78, s78, 24117248
    s_lshl_b32 s47, s41, 3
    s_add_u32 s67, s78, s47
    s_lshl_b32 s38, s39, 2
    s_add_u32 s67, s67, s38
    s_lshl_b32 s88, s41, 8
    s_lshl_b32 s47, s42, 3
    s_add_u32 s88, s88, s47
    s_add_u32 s88, s88, s38
    s_add_u32 s88, s88, 24133632
    s_lshl_b32 s47, s41, 1
    s_lshr_b32 s38, s40, 2
    s_add_u32 s47, s47, s38
    s_lshl_b32 s69, s47, 9
    s_lshl_b32 s47, s42, 4
    s_add_u32 s69, s69, s47
    s_and_b32 s47, s40, 3
    s_lshl_b32 s47, s47, 2
    s_add_u32 s69, s69, s47
    s_add_u32 s69, s69, 24137728
    s_cmp_lg_u32 s40, 0
    s_cbranch_scc1 K1_NOZ
    v_lshlrev_b32 v4, 2, v0
    v_lshrrev_b32 v6, 2, v0
    v_lshlrev_b32 v6, 9, v6
    v_and_b32 v7, 3, v0
    v_lshl_add_u32 v6, v7, 2, v6
    v_mov_b32 v5, 0
    s_mov_b64 exec, 3
    buffer_store_dword v5, v4, s[32:35], s67 offen sc1
    buffer_store_dword v5, v4, s[32:35], s88 offen sc1
    s_mov_b64 exec, 0xff
    buffer_store_dword v5, v4, s[32:35], s68 offen sc1
    buffer_store_dword v5, v6, s[32:35], s69 offen sc1
    s_mov_b32 s36, s86
    s_mov_b32 s37, s87
    s_mov_b32 s38, 256
    s_mov_b32 s39, 0x00020000
    s_mov_b64 exec, -1
K1_NOZ:
    s_load_dwordx2 s[4:5], s[0:1], 24
    s_load_dwordx2 s[6:7], s[0:1], 48
    s_load_dwordx2 s[8:9], s[0:1], 64
    s_lshr_b32 s16, s45, 1
    s_lshl_b32 s16, s16, 2
    s_lshr_b32 s47, s46, 3
    s_add_u32 s16, s16, s47
    s_and_b32 s17, s45, 1
    s_lshl_b32 s17, s17, 3
    s_and_b32 s47, s46, 7
    s_add_u32 s17, s17, s47
    s_lshr_b32 s18, s40, 2
    s_and_b32 s19, s40, 3
    s_lshl_b32 s47, s16, 2
    s_add_u32 s47, s47, s19
    s_lshl_b32 s28, s47, 16
    s_lshl_b32 s38, s18, 15
    s_add_u32 s28, s28, s38
    s_add_u32 s28, s28, 25165824
    s_lshl_b32 s31, s47, 7
    s_add_u32 s31, s31, 23134208
    s_lshr_b32 s47, s16, 1
    s_lshl_b32 s36, s47, 8
    s_add_u32 s36, s36, 24133632
    s_lshl_b32 s83, s16, 9
    s_add_u32 s83, s83, 24137728
    s_lshl_b32 s30, s18, 13
    s_lshl_b32 s38, s19, 11
    s_add_u32 s30, s30, s38
    s_mov_b32 s29, 0
    s_waitcnt lgkmcnt(0)
    s_mov_b32 s20, s4
    s_mov_b32 s21, s5
    s_mov_b32 s22, 2097152
    s_mov_b32 s23, 0x00020000
    s_lshr_b32 s50, s40, 1
    s_and_b32 s51, s40, 1
    v_and_b32 v4, 31, v0
    v_lshrrev_b32 v5, 5, v0
    v_bfe_u32 v6, v0, 2, 2
    v_bfe_u32 v7, v0, 1, 3
    v_xor_b32 v7, v5, v7
    v_lshlrev_b32 v7, 4, v7
    v_lshl_add_u32 v1, v4, 7, v7
    s_lshl_b32 s47, s50, 14
    v_add_u32 v1, s47, v1
    v_xor_b32 v2, 32, v1
    v_lshl_add_u32 v7, v5, 3, v6
    v_lshlrev_b32 v7, 6, v7
    v_bfe_u32 v8, v0, 4, 1
    v_lshl_add_u32 v7, v8, 5, v7
    v_and_b32 v9, 3, v0
    v_lshl_add_u32 v7, v9, 3, v7
    s_lshl_b32 s47, s51, 11
    s_add_u32 s47, s47, 98304
    v_add_u32 v3, s47, v7
    v_and_b32 v4, 15, v0
    v_lshrrev_b32 v5, 4, v0
    v_lshrrev_b32 v6, 1, v4
    v_xor_b32 v6, v5, v6
    v_lshlrev_b32 v6, 4, v6
    v_lshl_add_u32 v1, v4, 7, v6
    s_lshl_b32 s38, s50, 14
    v_add_u32 v1, s38, v1
    v_lshrrev_b32 v6, 2, v4
    v_lshl_add_u32 v6, v5, 3, v6
    v_lshlrev_b32 v6, 6, v6
    v_and_b32 v7, 1, v5
    v_lshl_add_u32 v6, v7, 5, v6
    v_and_b32 v7, 3, v0
    v_lshl_add_u32 v6, v7, 3, v6
    v_add_u32 v3, s47, v6
    v_xor_b32 v2, 32, v3
    s_mov_b32 s48, 1
    s_mov_b32 s49, 12288
    s_mov_b32 s65, 0
    s_mov_b32 s52, 12288
    s_mov_b32 s53, 4294918144
    s_mov_b32 s54, 32
    s_mov_b32 s64, 0
    s_mov_b32 s66, 4294901760
    v_mov_b32 v60, 0
    v_mov_b32 v61, 0
    v_mov_b32 v62, 0
    v_mov_b32 v63, 0
    v_mov_b32 v64, 0
    v_mov_b32 v65, 0
    v_mov_b32 v66, 0
    v_mov_b32 v67, 0
    v_mov_b32 v68, 0
    v_mov_b32 v69, 0
    v_mov_b32 v70, 0
    v_mov_b32 v71, 0
    v_mov_b32 v72, 0
    v_mov_b32 v73, 0
    v_mov_b32 v74, 0
    v_mov_b32 v75, 0
    v_mov_b32 v76, 0
    v_mov_b32 v77, 0
    v_mov_b32 v78, 0
    v_mov_b32 v79, 0
    v_mov_b32 v80, 0
    v_mov_b32 v81, 0
    v_mov_b32 v82, 0
    v_mov_b32 v83, 0
    v_mov_b32 v84, 0
    v_mov_b32 v85, 0
    v_mov_b32 v86, 0
    v_mov_b32 v87, 0
    v_mov_b32 v88, 0
    v_mov_b32 v89, 0
    v_mov_b32 v90, 0
    v_mov_b32 v91, 0
    v_mov_b32 v92, 0
    v_mov_b32 v93, 0
    v_mov_b32 v94, 0
    v_mov_b32 v95, 0
    v_mov_b32 v96, 0
    v_mov_b32 v97, 0
    v_mov_b32 v98, 0
    v_mov_b32 v99, 0
    v_mov_b32 v100, 0
    v_mov_b32 v101, 0
    v_mov_b32 v102, 0
    v_mov_b32 v103, 0
    v_mov_b32 v104, 0
    v_mov_b32 v105, 0
    v_mov_b32 v106, 0
    v_mov_b32 v107, 0
    v_mov_b32 v108, 0
    v_mov_b32 v109, 0
    v_mov_b32 v110, 0
    v_mov_b32 v111, 0
    v_mov_b32 v112, 0
    v_mov_b32 v113, 0
    v_mov_b32 v114, 0
    v_mov_b32 v115, 0
    v_mov_b32 v116, 0
    v_mov_b32 v117, 0
    v_mov_b32 v118, 0
    v_mov_b32 v119, 0
    v_mov_b32 v120, 0
    v_mov_b32 v121, 0
    v_mov_b32 v122, 0
    v_mov_b32 v123, 0
    v_mov_b32 v124, 0
    v_mov_b32 v125, 0
    v_mov_b32 v126, 0
    v_mov_b32 v127, 0
    v_mov_b32 v128, 0
    v_mov_b32 v129, 0
    v_mov_b32 v130, 0
    v_mov_b32 v131, 0
    v_mov_b32 v132, 0
    v_mov_b32 v133, 0
    v_mov_b32 v134, 0
    v_mov_b32 v135, 0
    v_mov_b32 v136, 0
    v_mov_b32 v137, 0
    v_mov_b32 v138, 0
    v_mov_b32 v139, 0
    v_mov_b32 v140, 0
    v_mov_b32 v141, 0
    v_mov_b32 v142, 0
    v_mov_b32 v143, 0
    v_mov_b32 v144, 0
    v_mov_b32 v145, 0
    v_mov_b32 v146, 0
    v_mov_b32 v147, 0
    v_mov_b32 v148, 0
    v_mov_b32 v149, 0
    v_mov_b32 v150, 0
    v_mov_b32 v151, 0
    v_mov_b32 v152, 0
    v_mov_b32 v153, 0
    v_mov_b32 v154, 0
    v_mov_b32 v155, 0
    v_mov_b32 v156, 0
    v_mov_b32 v157, 0
    v_mov_b32 v158, 0
    v_mov_b32 v159, 0
    v_mov_b32 v160, 0
    v_mov_b32 v161, 0
    v_mov_b32 v162, 0
    v_mov_b32 v163, 0
    v_mov_b32 v164, 0
    v_mov_b32 v165, 0
    v_mov_b32 v166, 0
    v_mov_b32 v167, 0
    v_mov_b32 v168, 0
    v_mov_b32 v169, 0
    v_mov_b32 v170, 0
    v_mov_b32 v171, 0
    v_mov_b32 v172, 0
    v_mov_b32 v173, 0
    v_mov_b32 v174, 0
    v_mov_b32 v175, 0
    v_mov_b32 v176, 0
    v_mov_b32 v177, 0
    v_mov_b32 v178, 0
    v_mov_b32 v179, 0
    v_mov_b32 v180, 0
    v_mov_b32 v181, 0
    v_mov_b32 v182, 0
    v_mov_b32 v183, 0
    v_mov_b32 v184, 0
    v_mov_b32 v185, 0
    v_mov_b32 v186, 0
    v_mov_b32 v187, 0
    v_mov_b32 v188, 0
    v_mov_b32 v189, 0
    v_mov_b32 v190, 0
    v_mov_b32 v191, 0
    v_mov_b32 v192, 0
    v_mov_b32 v193, 0
    v_mov_b32 v194, 0
    v_mov_b32 v195, 0
    v_mov_b32 v196, 0
    v_mov_b32 v197, 0
    v_mov_b32 v198, 0
    v_mov_b32 v199, 0
    v_mov_b32 v200, 0
    v_mov_b32 v201, 0
    v_mov_b32 v202, 0
    v_mov_b32 v203, 0
    v_mov_b32 v204, 0
    v_mov_b32 v205, 0
    v_mov_b32 v206, 0
    v_mov_b32 v207, 0
    v_mov_b32 v208, 0
    v_mov_b32 v209, 0
    v_mov_b32 v210, 0
    v_mov_b32 v211, 0
    v_mov_b32 v212, 0
    v_mov_b32 v213, 0
    v_mov_b32 v214, 0
    v_mov_b32 v215, 0
    v_mov_b32 v216, 0
    v_mov_b32 v217, 0
    v_mov_b32 v218, 0
    v_mov_b32 v219, 0
    v_mov_b32 v220, 0
    v_mov_b32 v221, 0
    v_mov_b32 v222, 0
    v_mov_b32 v223, 0
    v_mov_b32 v224, 0
    v_mov_b32 v225, 0
    v_mov_b32 v226, 0
    v_mov_b32 v227, 0
    v_mov_b32 v228, 0
    v_mov_b32 v229, 0
    v_mov_b32 v230, 0
    v_mov_b32 v231, 0
    v_mov_b32 v232, 0
    v_mov_b32 v233, 0
    v_mov_b32 v234, 0
    v_mov_b32 v235, 0
    v_mov_b32 v236, 0
    v_mov_b32 v237, 0
    v_mov_b32 v238, 0
    v_mov_b32 v239, 0
    v_mov_b32 v240, 0
    v_mov_b32 v241, 0
    v_mov_b32 v242, 0
    v_mov_b32 v243, 0
    v_mov_b32 v244, 0
    v_mov_b32 v245, 0
    v_mov_b32 v246, 0
    v_mov_b32 v247, 0
    v_mov_b32 v248, 0
    v_mov_b32 v249, 0
    v_mov_b32 v250, 0
    v_mov_b32 v251, 0
    s_barrier
    ds_read_b128 v[4:7], v1 offset:0
    ds_read_b128 v[8:11], v1 offset:2048
    ds_read_b128 v[12:15], v1 offset:4096
    ds_read_b64_tr_b16 v[36:37], v3 offset:0
    ds_read_b128 v[16:19], v1 offset:6144
    ds_read_b64_tr_b16 v[38:39], v3 offset:256
    ds_read_b64_tr_b16 v[40:41], v2 offset:0
    ds_read_b64_tr_b16 v[42:43], v2 offset:256
    ds_read_b64_tr_b16 v[44:45], v3 offset:4096
    ds_read_b64_tr_b16 v[46:47], v3 offset:4352
    ds_read_b64_tr_b16 v[48:49], v2 offset:4096
    ds_read_b64_tr_b16 v[50:51], v2 offset:4352
    ds_read_b64_tr_b16 v[52:53], v3 offset:8192
    ds_read_b64_tr_b16 v[54:55], v3 offset:8448
    ds_read_b64_tr_b16 v[56:57], v2 offset:8192
    ds_read_b64_tr_b16 v[58:59], v2 offset:8448
    s_cmp_lg_u32 s40, 0
    s_cbranch_scc1 K1_NOARR
    s_mov_b32 s96, s86
    s_mov_b32 s97, s87
    s_mov_b32 s98, 256
    s_mov_b32 s99, 0x00020000
    v_mov_b32 v32, 0
    v_mov_b32 v33, 1
    s_waitcnt vmcnt(0)
    s_mov_b64 exec, 1
    buffer_atomic_add v33, v32, s[96:99], 0 offen
    s_mov_b64 exec, -1
K1_NOARR:
    buffer_load_dword v253, v254, s[92:95], s55 offen
    s_add_u32 s55, s55, s59
K1_CLOOP:
    s_waitcnt lgkmcnt(10)
    v_mfma_f32_16x16x32_bf16 v[60:63], v[36:39], v[4:7], v[60:63]
    ds_read_b128 v[20:23], v1 offset:8192
    v_mfma_f32_16x16x32_bf16 v[68:71], v[36:39], v[8:11], v[68:71]
    ds_read_b128 v[24:27], v1 offset:10240
    v_mfma_f32_16x16x32_bf16 v[76:79], v[36:39], v[12:15], v[76:79]
    ds_read_b128 v[28:31], v1 offset:12288
    v_mfma_f32_16x16x32_bf16 v[84:87], v[36:39], v[16:19], v[84:87]
    ds_read_b128 v[32:35], v1 offset:14336
    s_waitcnt lgkmcnt(12)
    v_mfma_f32_16x16x32_bf16 v[64:67], v[40:43], v[4:7], v[64:67]
    v_xad_u32 v1, v1, 64, s65
    v_mfma_f32_16x16x32_bf16 v[72:75], v[40:43], v[8:11], v[72:75]
    v_mfma_f32_16x16x32_bf16 v[80:83], v[40:43], v[12:15], v[80:83]
    v_add_u32 v3, s49, v3
    v_mfma_f32_16x16x32_bf16 v[88:91], v[40:43], v[16:19], v[88:91]
    s_waitcnt lgkmcnt(10)
    v_mfma_f32_16x16x32_bf16 v[124:127], v[44:47], v[4:7], v[124:127]
    v_mfma_f32_16x16x32_bf16 v[132:135], v[44:47], v[8:11], v[132:135]
    v_add_u32 v2, s49, v2
    v_mfma_f32_16x16x32_bf16 v[140:143], v[44:47], v[12:15], v[140:143]
    v_mfma_f32_16x16x32_bf16 v[148:151], v[44:47], v[16:19], v[148:151]
    s_waitcnt lgkmcnt(8)
    v_mfma_f32_16x16x32_bf16 v[128:131], v[48:51], v[4:7], v[128:131]
    v_mfma_f32_16x16x32_bf16 v[136:139], v[48:51], v[8:11], v[136:139]
    v_mfma_f32_16x16x32_bf16 v[144:147], v[48:51], v[12:15], v[144:147]
    v_mfma_f32_16x16x32_bf16 v[152:155], v[48:51], v[16:19], v[152:155]
    s_waitcnt lgkmcnt(6)
    v_mfma_f32_16x16x32_bf16 v[188:191], v[4:7], v[52:55], v[188:191]
    v_mfma_f32_16x16x32_bf16 v[192:195], v[8:11], v[52:55], v[192:195]
    v_mfma_f32_16x16x32_bf16 v[204:207], v[12:15], v[52:55], v[204:207]
    v_mfma_f32_16x16x32_bf16 v[208:211], v[16:19], v[52:55], v[208:211]
    s_waitcnt lgkmcnt(4)
    v_mfma_f32_16x16x32_bf16 v[196:199], v[4:7], v[56:59], v[196:199]
    v_mfma_f32_16x16x32_bf16 v[200:203], v[8:11], v[56:59], v[200:203]
    v_mfma_f32_16x16x32_bf16 v[212:215], v[12:15], v[56:59], v[212:215]
    v_mfma_f32_16x16x32_bf16 v[216:219], v[16:19], v[56:59], v[216:219]
    s_waitcnt lgkmcnt(0)
    v_mfma_f32_16x16x32_bf16 v[92:95], v[36:39], v[20:23], v[92:95]
    ds_read_b128 v[4:7], v1 offset:0
    v_mfma_f32_16x16x32_bf16 v[100:103], v[36:39], v[24:27], v[100:103]
    ds_read_b128 v[8:11], v1 offset:2048
    v_mfma_f32_16x16x32_bf16 v[108:111], v[36:39], v[28:31], v[108:111]
    ds_read_b128 v[12:15], v1 offset:4096
    v_mfma_f32_16x16x32_bf16 v[116:119], v[36:39], v[32:35], v[116:119]
    ds_read_b64_tr_b16 v[36:37], v3 offset:0
    v_mfma_f32_16x16x32_bf16 v[96:99], v[40:43], v[20:23], v[96:99]
    ds_read_b128 v[16:19], v1 offset:6144
    ds_read_b64_tr_b16 v[38:39], v3 offset:256
    v_mfma_f32_16x16x32_bf16 v[104:107], v[40:43], v[24:27], v[104:107]
    s_sub_u32 s54, s54, 1
    s_and_b32 s63, s54, 1
    v_mfma_f32_16x16x32_bf16 v[112:115], v[40:43], v[28:31], v[112:115]
    s_add_u32 s64, s64, s63
    v_mfma_f32_16x16x32_bf16 v[120:123], v[40:43], v[32:35], v[120:123]
    ds_read_b64_tr_b16 v[40:41], v2 offset:0
    v_mfma_f32_16x16x32_bf16 v[156:159], v[44:47], v[20:23], v[156:159]
    ds_read_b64_tr_b16 v[42:43], v2 offset:256
    v_mfma_f32_16x16x32_bf16 v[164:167], v[44:47], v[24:27], v[164:167]
    s_cmp_eq_u32 s64, 3
    v_mfma_f32_16x16x32_bf16 v[172:175], v[44:47], v[28:31], v[172:175]
    s_cselect_b32 s65, s66, 32768
    v_mfma_f32_16x16x32_bf16 v[180:183], v[44:47], v[32:35], v[180:183]
    ds_read_b64_tr_b16 v[44:45], v3 offset:4096
    v_mfma_f32_16x16x32_bf16 v[160:163], v[48:51], v[20:23], v[160:163]
    ds_read_b64_tr_b16 v[46:47], v3 offset:4352
    v_mfma_f32_16x16x32_bf16 v[168:171], v[48:51], v[24:27], v[168:171]
    s_cselect_b32 s64, 0, s64
    v_mfma_f32_16x16x32_bf16 v[176:179], v[48:51], v[28:31], v[176:179]
    s_mul_i32 s65, s65, s63
    s_add_u32 s48, s48, 1
    v_mfma_f32_16x16x32_bf16 v[184:187], v[48:51], v[32:35], v[184:187]
    ds_read_b64_tr_b16 v[48:49], v2 offset:4096
    v_mfma_f32_16x16x32_bf16 v[220:223], v[20:23], v[52:55], v[220:223]
    ds_read_b64_tr_b16 v[50:51], v2 offset:4352
    v_mfma_f32_16x16x32_bf16 v[224:227], v[24:27], v[52:55], v[224:227]
    s_cmp_eq_u32 s48, 5
    v_mfma_f32_16x16x32_bf16 v[236:239], v[28:31], v[52:55], v[236:239]
    s_cselect_b32 s49, s53, s52
    v_mfma_f32_16x16x32_bf16 v[240:243], v[32:35], v[52:55], v[240:243]
    ds_read_b64_tr_b16 v[52:53], v3 offset:8192
    v_mfma_f32_16x16x32_bf16 v[228:231], v[20:23], v[56:59], v[228:231]
    ds_read_b64_tr_b16 v[54:55], v3 offset:8448
    v_mfma_f32_16x16x32_bf16 v[232:235], v[24:27], v[56:59], v[232:235]
    s_cselect_b32 s48, 0, s48
    v_mfma_f32_16x16x32_bf16 v[244:247], v[28:31], v[56:59], v[244:247]
    s_cmp_lg_u32 s54, 0
    v_mfma_f32_16x16x32_bf16 v[248:251], v[32:35], v[56:59], v[248:251]
    ds_read_b64_tr_b16 v[56:57], v2 offset:8192
    ds_read_b64_tr_b16 v[58:59], v2 offset:8448
    s_barrier
    s_cbranch_scc1 K1_CLOOP
    s_waitcnt lgkmcnt(0)
    v_and_b32 v42, 15, v0
    v_lshrrev_b32 v43, 4, v0
    v_lshlrev_b32 v1, 4, v42
    v_lshl_add_u32 v40, v43, 9, v1
    v_and_b32 v41, 1, v43
    v_lshl_add_u32 v41, v41, 10, v1
    v_lshrrev_b32 v43, 1, v43
    v_lshl_add_u32 v41, v43, 9, v41
    v_lshrrev_b32 v42, 3, v42
    v_lshl_add_u32 v42, v42, 7, v40
    v_lshlrev_b32 v1, 4, v0
    s_cmp_lg_u32 s51, 0
    s_cbranch_scc1 K1_E1T1
    s_mov_b32 s56, 0x3e8293ee
    s_mov_b32 s57, s56
    s_lshl_b32 s47, s50, 13
    s_add_u32 s47, s47, 65536
    v_add_u32 v44, s47, v40
    s_lshl_b32 s47, s50, 13
    s_add_u32 s47, s47, 122880
    v_add_u32 v45, s47, v41
    s_nop 1
    v_cvt_pk_bf16_f32 v4, v92, v93
    v_cvt_pk_bf16_f32 v5, v94, v95
    v_cvt_pk_bf16_f32 v6, v96, v97
    v_cvt_pk_bf16_f32 v7, v98, v99
    v_cvt_pk_bf16_f32 v8, v100, v101
    v_cvt_pk_bf16_f32 v9, v102, v103
    v_cvt_pk_bf16_f32 v10, v104, v105
    v_cvt_pk_bf16_f32 v11, v106, v107
    ds_write_b128 v45, v[4:7] offset:0
    ds_write_b128 v45, v[8:11] offset:256
    v_cvt_pk_bf16_f32 v12, v108, v109
    v_cvt_pk_bf16_f32 v13, v110, v111
    v_cvt_pk_bf16_f32 v14, v112, v113
    v_cvt_pk_bf16_f32 v15, v114, v115
    v_cvt_pk_bf16_f32 v16, v116, v117
    v_cvt_pk_bf16_f32 v17, v118, v119
    v_cvt_pk_bf16_f32 v18, v120, v121
    v_cvt_pk_bf16_f32 v19, v122, v123
    ds_write_b128 v45, v[12:15] offset:2048
    ds_write_b128 v45, v[16:19] offset:2304
    v_cvt_pk_bf16_f32 v20, v220, v221
    v_cvt_pk_bf16_f32 v21, v222, v223
    v_cvt_pk_bf16_f32 v22, v224, v225
    v_cvt_pk_bf16_f32 v23, v226, v227
    v_cvt_pk_bf16_f32 v24, v228, v229
    v_cvt_pk_bf16_f32 v25, v230, v231
    v_cvt_pk_bf16_f32 v26, v232, v233
    v_cvt_pk_bf16_f32 v27, v234, v235
    ds_write_b128 v45, v[20:23] offset:4096
    ds_write_b128 v45, v[24:27] offset:4352
    v_cvt_pk_bf16_f32 v28, v236, v237
    v_cvt_pk_bf16_f32 v29, v238, v239
    v_cvt_pk_bf16_f32 v30, v240, v241
    v_cvt_pk_bf16_f32 v31, v242, v243
    v_cvt_pk_bf16_f32 v32, v244, v245
    v_cvt_pk_bf16_f32 v33, v246, v247
    v_cvt_pk_bf16_f32 v34, v248, v249
    v_cvt_pk_bf16_f32 v35, v250, v251
    ds_write_b128 v45, v[28:31] offset:6144
    ds_write_b128 v45, v[32:35] offset:6400
    s_waitcnt lgkmcnt(0)
    s_barrier
    v_mov_b32 v26, v44
    s_mov_b32 s64, s56
    s_mov_b32 s65, s56
    v_cvt_pk_bf16_f32 v92, v188, v189
    v_cvt_pk_bf16_f32 v93, v190, v191
    v_cvt_pk_bf16_f32 v94, v192, v193
    v_cvt_pk_bf16_f32 v95, v194, v195
    v_cvt_pk_bf16_f32 v96, v196, v197
    v_cvt_pk_bf16_f32 v97, v198, v199
    v_cvt_pk_bf16_f32 v98, v200, v201
    v_cvt_pk_bf16_f32 v99, v202, v203
    v_permlane16_swap_b32 v92, v96
    v_permlane16_swap_b32 v93, v97
    v_permlane16_swap_b32 v94, v98
    v_permlane16_swap_b32 v95, v99
    v_cvt_pk_bf16_f32 v100, v204, v205
    v_cvt_pk_bf16_f32 v101, v206, v207
    v_cvt_pk_bf16_f32 v102, v208, v209
    v_cvt_pk_bf16_f32 v103, v210, v211
    v_cvt_pk_bf16_f32 v104, v212, v213
    v_cvt_pk_bf16_f32 v105, v214, v215
    v_cvt_pk_bf16_f32 v106, v216, v217
    v_cvt_pk_bf16_f32 v107, v218, v219
    v_permlane16_swap_b32 v100, v104
    v_permlane16_swap_b32 v101, v105
    v_permlane16_swap_b32 v102, v106
    v_permlane16_swap_b32 v103, v107
    s_branch K1_E2J
K1_E1T1:
    s_lshl_b32 s58, s41, 1
    s_add_u32 s58, s58, s50
    s_lshl_b32 s58, s58, 14
    s_add_u32 s58, s58, s70
    s_lshl_b32 s47, s50, 14
    v_add_u32 v44, s47, v42
    v_add_u32 v43, s47, v40
    s_lshl_b32 s47, s50, 12
    s_add_u32 s47, s47, 139264
    v_add_u32 v45, s47, v41
    v_cvt_pk_bf16_f32 v4, v92, v93
    v_cvt_pk_bf16_f32 v5, v94, v95
    v_cvt_pk_bf16_f32 v6, v96, v97
    v_cvt_pk_bf16_f32 v7, v98, v99
    v_cvt_pk_bf16_f32 v8, v100, v101
    v_cvt_pk_bf16_f32 v9, v102, v103
    v_cvt_pk_bf16_f32 v10, v104, v105
    v_cvt_pk_bf16_f32 v11, v106, v107
    ds_write_b128 v45, v[4:7] offset:0
    ds_write_b128 v45, v[8:11] offset:256
    v_cvt_pk_bf16_f32 v12, v108, v109
    v_cvt_pk_bf16_f32 v13, v110, v111
    v_cvt_pk_bf16_f32 v14, v112, v113
    v_cvt_pk_bf16_f32 v15, v114, v115
    v_cvt_pk_bf16_f32 v16, v116, v117
    v_cvt_pk_bf16_f32 v17, v118, v119
    v_cvt_pk_bf16_f32 v18, v120, v121
    v_cvt_pk_bf16_f32 v19, v122, v123
    ds_write_b128 v45, v[12:15] offset:2048
    ds_write_b128 v45, v[16:19] offset:2304
    v_cvt_pk_bf16_f32 v20, v156, v157
    v_cvt_pk_bf16_f32 v21, v158, v159
    v_cvt_pk_bf16_f32 v22, v160, v161
    v_cvt_pk_bf16_f32 v23, v162, v163
    v_cvt_pk_bf16_f32 v24, v164, v165
    v_cvt_pk_bf16_f32 v25, v166, v167
    v_cvt_pk_bf16_f32 v26, v168, v169
    v_cvt_pk_bf16_f32 v27, v170, v171
    s_add_u32 s47, s58, 8192
    buffer_store_dwordx4 v[20:23], v42, s[32:35], s47 offen sc1
    buffer_store_dwordx4 v[24:27], v42, s[32:35], s47 offen offset:128 sc1
    v_cvt_pk_bf16_f32 v28, v172, v173
    v_cvt_pk_bf16_f32 v29, v174, v175
    v_cvt_pk_bf16_f32 v30, v176, v177
    v_cvt_pk_bf16_f32 v31, v178, v179
    v_cvt_pk_bf16_f32 v32, v180, v181
    v_cvt_pk_bf16_f32 v33, v182, v183
    v_cvt_pk_bf16_f32 v34, v184, v185
    v_cvt_pk_bf16_f32 v35, v186, v187
    s_add_u32 s47, s58, 12288
    buffer_store_dwordx4 v[28:31], v42, s[32:35], s47 offen sc1
    buffer_store_dwordx4 v[32:35], v42, s[32:35], s47 offen offset:128 sc1
    s_waitcnt lgkmcnt(0)
    s_barrier
    v_cvt_pk_bf16_f32 v4, v124, v125
    v_cvt_pk_bf16_f32 v5, v126, v127
    v_cvt_pk_bf16_f32 v6, v128, v129
    v_cvt_pk_bf16_f32 v7, v130, v131
    v_cvt_pk_bf16_f32 v8, v132, v133
    v_cvt_pk_bf16_f32 v9, v134, v135
    v_cvt_pk_bf16_f32 v10, v136, v137
    v_cvt_pk_bf16_f32 v11, v138, v139
    s_add_u32 s47, s58, 0
    buffer_store_dwordx4 v[4:7], v42, s[32:35], s47 offen sc1
    buffer_store_dwordx4 v[8:11], v42, s[32:35], s47 offen offset:128 sc1
    v_cvt_pk_bf16_f32 v12, v140, v141
    v_cvt_pk_bf16_f32 v13, v142, v143
    v_cvt_pk_bf16_f32 v14, v144, v145
    v_cvt_pk_bf16_f32 v15, v146, v147
    v_cvt_pk_bf16_f32 v16, v148, v149
    v_cvt_pk_bf16_f32 v17, v150, v151
    v_cvt_pk_bf16_f32 v18, v152, v153
    v_cvt_pk_bf16_f32 v19, v154, v155
    s_add_u32 s47, s58, 4096
    buffer_store_dwordx4 v[12:15], v42, s[32:35], s47 offen sc1
    buffer_store_dwordx4 v[16:19], v42, s[32:35], s47 offen offset:128 sc1
    s_add_u32 s58, s58, 2048
    v_cvt_pk_bf16_f32 v124, v188, v189
    v_cvt_pk_bf16_f32 v125, v190, v191
    v_cvt_pk_bf16_f32 v126, v192, v193
    v_cvt_pk_bf16_f32 v127, v194, v195
    v_cvt_pk_bf16_f32 v128, v196, v197
    v_cvt_pk_bf16_f32 v129, v198, v199
    v_cvt_pk_bf16_f32 v130, v200, v201
    v_cvt_pk_bf16_f32 v131, v202, v203
    buffer_store_dwordx4 v[124:127], v40, s[32:35], s58 offen sc1
    buffer_store_dwordx4 v[128:131], v40, s[32:35], s58 offen offset:256 sc1
    s_add_u32 s58, s58, 4096
    v_cvt_pk_bf16_f32 v132, v204, v205
    v_cvt_pk_bf16_f32 v133, v206, v207
    v_cvt_pk_bf16_f32 v134, v208, v209
    v_cvt_pk_bf16_f32 v135, v210, v211
    v_cvt_pk_bf16_f32 v136, v212, v213
    v_cvt_pk_bf16_f32 v137, v214, v215
    v_cvt_pk_bf16_f32 v138, v216, v217
    v_cvt_pk_bf16_f32 v139, v218, v219
    buffer_store_dwordx4 v[132:135], v40, s[32:35], s58 offen sc1
    buffer_store_dwordx4 v[136:139], v40, s[32:35], s58 offen offset:256 sc1
    s_add_u32 s58, s58, 4096
    v_cvt_pk_bf16_f32 v140, v220, v221
    v_cvt_pk_bf16_f32 v141, v222, v223
    v_cvt_pk_bf16_f32 v142, v224, v225
    v_cvt_pk_bf16_f32 v143, v226, v227
    v_cvt_pk_bf16_f32 v144, v228, v229
    v_cvt_pk_bf16_f32 v145, v230, v231
    v_cvt_pk_bf16_f32 v146, v232, v233
    v_cvt_pk_bf16_f32 v147, v234, v235
    buffer_store_dwordx4 v[140:143], v40, s[32:35], s58 offen sc1
    buffer_store_dwordx4 v[144:147], v40, s[32:35], s58 offen offset:256 sc1
    s_add_u32 s58, s58, 4096
    v_cvt_pk_bf16_f32 v148, v236, v237
    v_cvt_pk_bf16_f32 v149, v238, v239
    v_cvt_pk_bf16_f32 v150, v240, v241
    v_cvt_pk_bf16_f32 v151, v242, v243
    v_cvt_pk_bf16_f32 v152, v244, v245
    v_cvt_pk_bf16_f32 v153, v246, v247
    v_cvt_pk_bf16_f32 v154, v248, v249
    v_cvt_pk_bf16_f32 v155, v250, v251
    buffer_store_dwordx4 v[148:151], v40, s[32:35], s58 offen sc1
    buffer_store_dwordx4 v[152:155], v40, s[32:35], s58 offen offset:256 sc1
    s_add_u32 s58, s58, 4096
    ds_write_b128 v44, v[4:7] offset:0
    ds_write_b128 v44, v[8:11] offset:128
    ds_write_b128 v43, v[124:127] offset:2048
    ds_write_b128 v43, v[128:131] offset:2304
    ds_write_b128 v44, v[12:15] offset:4096
    ds_write_b128 v44, v[16:19] offset:4224
    ds_write_b128 v43, v[132:135] offset:6144
    ds_write_b128 v43, v[136:139] offset:6400
    ds_write_b128 v44, v[20:23] offset:8192
    ds_write_b128 v44, v[24:27] offset:8320
    ds_write_b128 v43, v[140:143] offset:10240
    ds_write_b128 v43, v[144:147] offset:10496
    ds_write_b128 v44, v[28:31] offset:12288
    ds_write_b128 v44, v[32:35] offset:12416
    ds_write_b128 v43, v[148:151] offset:14336
    ds_write_b128 v43, v[152:155] offset:14592
K1_E2J:
    v_lshrrev_b32 v5, 5, v0
    v_bfe_u32 v6, v0, 2, 2
    v_lshl_add_u32 v6, v5, 3, v6
    v_bfe_u32 v7, v0, 4, 1
    v_lshlrev_b32 v7, 5, v7
    v_and_b32 v8, 3, v0
    v_lshl_add_u32 v7, v8, 3, v7
    v_lshl_add_u32 v2, v6, 6, v7
    v_add_u32 v2, 159744, v2
    ds_read_b64_tr_b16 v[36:37], v2 offset:0
    ds_read_b64_tr_b16 v[38:39], v2 offset:1024
    ds_read_b64_tr_b16 v[40:41], v2 offset:256
    ds_read_b64_tr_b16 v[42:43], v2 offset:1280
    s_mul_i32 s47, s50, 4352
    s_add_u32 s47, s47, 81920
    v_mul_u32_u24 v25, 136, v6
    v_add_u32 v25, v25, v7
    v_add_u32 v25, s47, v25
    v_and_b32 v8, 31, v0
    v_mul_u32_u24 v24, 136, v8
    v_lshl_add_u32 v24, v5, 3, v24
    v_add_u32 v24, s47, v24
    v_bfe_u32 v8, v0, 2, 1
    v_bfe_u32 v9, v0, 4, 1
    v_cmp_eq_u32 vcc, v8, v9
    v_mov_b32 v9, 0x3f803f80
    v_mov_b32 v8, 0
    v_cndmask_b32 v20, v8, v9, vcc
    v_cndmask_b32 v21, v8, v9, vcc
    v_cndmask_b32 v22, v8, v9, vcc
    v_cndmask_b32 v23, v8, v9, vcc
    v_cvt_pk_bf16_f32 v108, v60, v61
    v_cvt_pk_bf16_f32 v109, v62, v63
    v_cvt_pk_bf16_f32 v110, v64, v65
    v_cvt_pk_bf16_f32 v111, v66, v67
    v_cvt_pk_bf16_f32 v112, v68, v69
    v_cvt_pk_bf16_f32 v113, v70, v71
    v_cvt_pk_bf16_f32 v114, v72, v73
    v_cvt_pk_bf16_f32 v115, v74, v75
    v_permlane16_swap_b32 v108, v112
    v_permlane16_swap_b32 v109, v113
    v_permlane16_swap_b32 v110, v114
    v_permlane16_swap_b32 v111, v115
    v_cvt_pk_bf16_f32 v116, v76, v77
    v_cvt_pk_bf16_f32 v117, v78, v79
    v_cvt_pk_bf16_f32 v118, v80, v81
    v_cvt_pk_bf16_f32 v119, v82, v83
    v_cvt_pk_bf16_f32 v120, v84, v85
    v_cvt_pk_bf16_f32 v121, v86, v87
    v_cvt_pk_bf16_f32 v122, v88, v89
    v_cvt_pk_bf16_f32 v123, v90, v91
    v_permlane16_swap_b32 v116, v120
    v_permlane16_swap_b32 v117, v121
    v_permlane16_swap_b32 v118, v122
    v_permlane16_swap_b32 v119, v123
    s_nop 0
K1_E2L:
    s_waitcnt lgkmcnt(0)
    v_mfma_f32_32x32x16_bf16 v[60:75], v[36:39], v[108:111], 0
    v_mfma_f32_32x32x16_bf16 v[76:91], v[36:39], v[116:119], 0
    v_mfma_f32_32x32x16_bf16 v[60:75], v[40:43], v[112:115], v[60:75]
    v_mfma_f32_32x32x16_bf16 v[76:91], v[40:43], v[120:123], v[76:91]
    s_mov_b32 s56, 0x3fb8aa3b
    s_mov_b32 s57, s56
    s_cmp_ge_u32 s40, 4
    s_cbranch_scc1 K1_F1E_1
    s_cmp_eq_u32 s51, 0
    s_cbranch_scc1 K1_F1E_1
    s_waitcnt vmcnt(0)
    s_mov_b64 exec, 1
    v_mov_b32 v4, 1
    v_mov_b32 v5, 0
    buffer_store_dword v4, v5, s[32:35], s67 offen sc1
    s_mov_b64 exec, -1
K1_F1E_1:
    s_nop 9
    v_max3_f32 v4, v60, v61, v62
    v_max3_f32 v5, -v60, -v61, -v62
    v_max3_f32 v4, v4, v63, v64
    v_max3_f32 v5, v5, -v63, -v64
    v_max3_f32 v4, v4, v65, v66
    v_max3_f32 v5, v5, -v65, -v66
    v_max3_f32 v4, v4, v67, v68
    v_max3_f32 v5, v5, -v67, -v68
    v_max3_f32 v4, v4, v69, v70
    v_max3_f32 v5, v5, -v69, -v70
    v_max3_f32 v4, v4, v71, v72
    v_max3_f32 v5, v5, -v71, -v72
    v_max3_f32 v4, v4, v73, v74
    v_max3_f32 v5, v5, -v73, -v74
    v_max_f32 v4, v4, v75
    v_max_f32 v5, v5, -v75
    s_nop 1
    v_permlane32_swap_b32 v4, v5
    s_nop 0
    v_max_f32 v4, v4, v5
    v_mov_b32 v5, v4
    s_nop 1
    v_permlane32_swap_b32 v4, v5
    s_nop 0
    v_mul_f32 v6, 0xbfb8aa3b, v4
    v_mul_f32 v8, 0xbfb8aa3b, v5
    v_pk_fma_f32 v[188:189], v[60:61], s[56:57], v[6:7] op_sel_hi:[1,1,0]
    v_pk_fma_f32 v[60:61], v[60:61], s[56:57], v[8:9] op_sel_hi:[1,1,0] neg_lo:[0,1,0] neg_hi:[0,1,0]
    v_pk_fma_f32 v[190:191], v[62:63], s[56:57], v[6:7] op_sel_hi:[1,1,0]
    v_pk_fma_f32 v[62:63], v[62:63], s[56:57], v[8:9] op_sel_hi:[1,1,0] neg_lo:[0,1,0] neg_hi:[0,1,0]
    v_pk_fma_f32 v[192:193], v[64:65], s[56:57], v[6:7] op_sel_hi:[1,1,0]
    v_pk_fma_f32 v[64:65], v[64:65], s[56:57], v[8:9] op_sel_hi:[1,1,0] neg_lo:[0,1,0] neg_hi:[0,1,0]
    v_pk_fma_f32 v[194:195], v[66:67], s[56:57], v[6:7] op_sel_hi:[1,1,0]
    v_pk_fma_f32 v[66:67], v[66:67], s[56:57], v[8:9] op_sel_hi:[1,1,0] neg_lo:[0,1,0] neg_hi:[0,1,0]
    v_pk_fma_f32 v[196:197], v[68:69], s[56:57], v[6:7] op_sel_hi:[1,1,0]
    v_pk_fma_f32 v[68:69], v[68:69], s[56:57], v[8:9] op_sel_hi:[1,1,0] neg_lo:[0,1,0] neg_hi:[0,1,0]
    v_pk_fma_f32 v[198:199], v[70:71], s[56:57], v[6:7] op_sel_hi:[1,1,0]
    v_pk_fma_f32 v[70:71], v[70:71], s[56:57], v[8:9] op_sel_hi:[1,1,0] neg_lo:[0,1,0] neg_hi:[0,1,0]
    v_pk_fma_f32 v[200:201], v[72:73], s[56:57], v[6:7] op_sel_hi:[1,1,0]
    v_pk_fma_f32 v[72:73], v[72:73], s[56:57], v[8:9] op_sel_hi:[1,1,0] neg_lo:[0,1,0] neg_hi:[0,1,0]
    v_pk_fma_f32 v[202:203], v[74:75], s[56:57], v[6:7] op_sel_hi:[1,1,0]
    v_pk_fma_f32 v[74:75], v[74:75], s[56:57], v[8:9] op_sel_hi:[1,1,0] neg_lo:[0,1,0] neg_hi:[0,1,0]
    v_exp_f32 v188, v188
    v_exp_f32 v60, v60
    v_exp_f32 v189, v189
    v_exp_f32 v61, v61
    v_exp_f32 v190, v190
    v_exp_f32 v62, v62
    v_exp_f32 v191, v191
    v_exp_f32 v63, v63
    v_exp_f32 v192, v192
    v_exp_f32 v64, v64
    v_exp_f32 v193, v193
    v_exp_f32 v65, v65
    v_exp_f32 v194, v194
    v_exp_f32 v66, v66
    v_exp_f32 v195, v195
    v_exp_f32 v67, v67
    v_exp_f32 v196, v196
    v_exp_f32 v68, v68
    v_exp_f32 v197, v197
    v_exp_f32 v69, v69
    v_exp_f32 v198, v198
    v_exp_f32 v70, v70
    v_exp_f32 v199, v199
    v_exp_f32 v71, v71
    v_exp_f32 v200, v200
    v_exp_f32 v72, v72
    v_exp_f32 v201, v201
    v_exp_f32 v73, v73
    v_exp_f32 v202, v202
    v_exp_f32 v74, v74
    v_exp_f32 v203, v203
    v_exp_f32 v75, v75
    v_pk_add_f32 v[4:5], v[188:189], v[190:191]
    v_pk_add_f32 v[6:7], v[60:61], v[62:63]
    v_pk_add_f32 v[4:5], v[4:5], v[192:193]
    v_pk_add_f32 v[6:7], v[6:7], v[64:65]
    v_pk_add_f32 v[4:5], v[4:5], v[194:195]
    v_pk_add_f32 v[6:7], v[6:7], v[66:67]
    v_pk_add_f32 v[4:5], v[4:5], v[196:197]
    v_pk_add_f32 v[6:7], v[6:7], v[68:69]
    v_pk_add_f32 v[4:5], v[4:5], v[198:199]
    v_pk_add_f32 v[6:7], v[6:7], v[70:71]
    v_pk_add_f32 v[4:5], v[4:5], v[200:201]
    v_pk_add_f32 v[6:7], v[6:7], v[72:73]
    v_pk_add_f32 v[4:5], v[4:5], v[202:203]
    v_pk_add_f32 v[6:7], v[6:7], v[74:75]
    v_add_f32 v4, v4, v5
    v_add_f32 v6, v6, v7
    s_nop 1
    v_permlane32_swap_b32 v4, v6
    s_nop 0
    v_add_f32 v4, v4, v6
    v_rcp_f32 v4, v4
    s_nop 0
    v_mov_b32 v6, v4
    s_nop 1
    v_permlane32_swap_b32 v4, v6
    s_nop 0
    v_pk_mul_f32 v[188:189], v[188:189], v[4:5] op_sel_hi:[1,0]
    v_pk_mul_f32 v[60:61], v[60:61], v[6:7] op_sel_hi:[1,0]
    v_pk_mul_f32 v[190:191], v[190:191], v[4:5] op_sel_hi:[1,0]
    v_pk_mul_f32 v[62:63], v[62:63], v[6:7] op_sel_hi:[1,0]
    v_pk_mul_f32 v[192:193], v[192:193], v[4:5] op_sel_hi:[1,0]
    v_pk_mul_f32 v[64:65], v[64:65], v[6:7] op_sel_hi:[1,0]
    v_pk_mul_f32 v[194:195], v[194:195], v[4:5] op_sel_hi:[1,0]
    v_pk_mul_f32 v[66:67], v[66:67], v[6:7] op_sel_hi:[1,0]
    v_pk_mul_f32 v[196:197], v[196:197], v[4:5] op_sel_hi:[1,0]
    v_pk_mul_f32 v[68:69], v[68:69], v[6:7] op_sel_hi:[1,0]
    v_pk_mul_f32 v[198:199], v[198:199], v[4:5] op_sel_hi:[1,0]
    v_pk_mul_f32 v[70:71], v[70:71], v[6:7] op_sel_hi:[1,0]
    v_pk_mul_f32 v[200:201], v[200:201], v[4:5] op_sel_hi:[1,0]
    v_pk_mul_f32 v[72:73], v[72:73], v[6:7] op_sel_hi:[1,0]
    v_pk_mul_f32 v[202:203], v[202:203], v[4:5] op_sel_hi:[1,0]
    v_pk_mul_f32 v[74:75], v[74:75], v[6:7] op_sel_hi:[1,0]
    s_cmp_eq_u32 s51, 0
    s_cbranch_scc1 K1_T0_2
    v_cvt_pk_bf16_f32 v128, v188, v189
    v_cvt_pk_bf16_f32 v129, v190, v191
    v_cvt_pk_bf16_f32 v130, v192, v193
    v_cvt_pk_bf16_f32 v131, v194, v195
    v_cvt_pk_bf16_f32 v132, v196, v197
    v_cvt_pk_bf16_f32 v133, v198, v199
    v_cvt_pk_bf16_f32 v134, v200, v201
    v_cvt_pk_bf16_f32 v135, v202, v203
    v_cvt_pk_bf16_f32 v136, v60, v61
    v_cvt_pk_bf16_f32 v137, v62, v63
    v_cvt_pk_bf16_f32 v138, v64, v65
    v_cvt_pk_bf16_f32 v139, v66, v67
    v_cvt_pk_bf16_f32 v140, v68, v69
    v_cvt_pk_bf16_f32 v141, v70, v71
    v_cvt_pk_bf16_f32 v142, v72, v73
    v_cvt_pk_bf16_f32 v143, v74, v75
    s_branch K1_TJ_3
K1_T0_2:
    v_cvt_pk_bf16_f32 v204, v188, v189
    v_cvt_pk_bf16_f32 v205, v190, v191
    v_cvt_pk_bf16_f32 v206, v192, v193
    v_cvt_pk_bf16_f32 v207, v194, v195
    v_cvt_pk_bf16_f32 v208, v196, v197
    v_cvt_pk_bf16_f32 v209, v198, v199
    v_cvt_pk_bf16_f32 v210, v200, v201
    v_cvt_pk_bf16_f32 v211, v202, v203
    v_cvt_pk_bf16_f32 v212, v60, v61
    v_cvt_pk_bf16_f32 v213, v62, v63
    v_cvt_pk_bf16_f32 v214, v64, v65
    v_cvt_pk_bf16_f32 v215, v66, v67
    v_cvt_pk_bf16_f32 v216, v68, v69
    v_cvt_pk_bf16_f32 v217, v70, v71
    v_cvt_pk_bf16_f32 v218, v72, v73
    v_cvt_pk_bf16_f32 v219, v74, v75
    ds_write_b64 v24, v[204:205] offset:0
    ds_write_b64 v24, v[206:207] offset:16
    ds_write_b64 v24, v[208:209] offset:32
    ds_write_b64 v24, v[210:211] offset:48
    ds_write_b64 v24, v[212:213] offset:64
    ds_write_b64 v24, v[214:215] offset:80
    ds_write_b64 v24, v[216:217] offset:96
    ds_write_b64 v24, v[218:219] offset:112
    ds_read_b64_tr_b16 v[220:221], v25 offset:0
    ds_read_b64_tr_b16 v[222:223], v25 offset:2176
    ds_read_b64_tr_b16 v[224:225], v25 offset:544
    ds_read_b64_tr_b16 v[226:227], v25 offset:2720
    ds_read_b64_tr_b16 v[228:229], v25 offset:64
    ds_read_b64_tr_b16 v[230:231], v25 offset:2240
    ds_read_b64_tr_b16 v[232:233], v25 offset:608
    ds_read_b64_tr_b16 v[234:235], v25 offset:2784
K1_TJ_3:
    s_cmp_lt_u32 s40, 4
    s_cbranch_scc1 K1_TP_4
    s_cmp_lg_u32 s51, 0
    s_cbranch_scc1 K1_TP_4
    s_setprio 1
K1_TP_4:
    v_max3_f32 v4, v76, v77, v78
    v_max3_f32 v5, -v76, -v77, -v78
    v_max3_f32 v4, v4, v79, v80
    v_max3_f32 v5, v5, -v79, -v80
    v_max3_f32 v4, v4, v81, v82
    v_max3_f32 v5, v5, -v81, -v82
    v_max3_f32 v4, v4, v83, v84
    v_max3_f32 v5, v5, -v83, -v84
    v_max3_f32 v4, v4, v85, v86
    v_max3_f32 v5, v5, -v85, -v86
    v_max3_f32 v4, v4, v87, v88
    v_max3_f32 v5, v5, -v87, -v88
    v_max3_f32 v4, v4, v89, v90
    v_max3_f32 v5, v5, -v89, -v90
    v_max_f32 v4, v4, v91
    v_max_f32 v5, v5, -v91
    s_nop 1
    v_permlane32_swap_b32 v4, v5
    s_nop 0
    v_max_f32 v4, v4, v5
    v_mov_b32 v5, v4
    s_nop 1
    v_permlane32_swap_b32 v4, v5
    s_nop 0
    v_mul_f32 v6, 0xbfb8aa3b, v4
    v_mul_f32 v8, 0xbfb8aa3b, v5
    v_pk_fma_f32 v[188:189], v[76:77], s[56:57], v[6:7] op_sel_hi:[1,1,0]
    v_pk_fma_f32 v[76:77], v[76:77], s[56:57], v[8:9] op_sel_hi:[1,1,0] neg_lo:[0,1,0] neg_hi:[0,1,0]
    v_pk_fma_f32 v[190:191], v[78:79], s[56:57], v[6:7] op_sel_hi:[1,1,0]
    v_pk_fma_f32 v[78:79], v[78:79], s[56:57], v[8:9] op_sel_hi:[1,1,0] neg_lo:[0,1,0] neg_hi:[0,1,0]
    v_pk_fma_f32 v[192:193], v[80:81], s[56:57], v[6:7] op_sel_hi:[1,1,0]
    v_pk_fma_f32 v[80:81], v[80:81], s[56:57], v[8:9] op_sel_hi:[1,1,0] neg_lo:[0,1,0] neg_hi:[0,1,0]
    v_pk_fma_f32 v[194:195], v[82:83], s[56:57], v[6:7] op_sel_hi:[1,1,0]
    v_pk_fma_f32 v[82:83], v[82:83], s[56:57], v[8:9] op_sel_hi:[1,1,0] neg_lo:[0,1,0] neg_hi:[0,1,0]
    v_pk_fma_f32 v[196:197], v[84:85], s[56:57], v[6:7] op_sel_hi:[1,1,0]
    v_pk_fma_f32 v[84:85], v[84:85], s[56:57], v[8:9] op_sel_hi:[1,1,0] neg_lo:[0,1,0] neg_hi:[0,1,0]
    v_pk_fma_f32 v[198:199], v[86:87], s[56:57], v[6:7] op_sel_hi:[1,1,0]
    v_pk_fma_f32 v[86:87], v[86:87], s[56:57], v[8:9] op_sel_hi:[1,1,0] neg_lo:[0,1,0] neg_hi:[0,1,0]
    v_pk_fma_f32 v[200:201], v[88:89], s[56:57], v[6:7] op_sel_hi:[1,1,0]
    v_pk_fma_f32 v[88:89], v[88:89], s[56:57], v[8:9] op_sel_hi:[1,1,0] neg_lo:[0,1,0] neg_hi:[0,1,0]
    v_pk_fma_f32 v[202:203], v[90:91], s[56:57], v[6:7] op_sel_hi:[1,1,0]
    v_pk_fma_f32 v[90:91], v[90:91], s[56:57], v[8:9] op_sel_hi:[1,1,0] neg_lo:[0,1,0] neg_hi:[0,1,0]
    v_exp_f32 v188, v188
    v_exp_f32 v76, v76
    v_exp_f32 v189, v189
    v_exp_f32 v77, v77
    v_exp_f32 v190, v190
    v_exp_f32 v78, v78
    v_exp_f32 v191, v191
    v_exp_f32 v79, v79
    v_exp_f32 v192, v192
    v_exp_f32 v80, v80
    v_exp_f32 v193, v193
    v_exp_f32 v81, v81
    v_exp_f32 v194, v194
    v_exp_f32 v82, v82
    v_exp_f32 v195, v195
    v_exp_f32 v83, v83
    v_exp_f32 v196, v196
    v_exp_f32 v84, v84
    v_exp_f32 v197, v197
    v_exp_f32 v85, v85
    v_exp_f32 v198, v198
    v_exp_f32 v86, v86
    v_exp_f32 v199, v199
    v_exp_f32 v87, v87
    v_exp_f32 v200, v200
    v_exp_f32 v88, v88
    v_exp_f32 v201, v201
    v_exp_f32 v89, v89
    v_exp_f32 v202, v202
    v_exp_f32 v90, v90
    v_exp_f32 v203, v203
    v_exp_f32 v91, v91
    s_cmp_lg_u32 s51, 0
    s_cbranch_scc1 K1_KVS_5
    s_waitcnt lgkmcnt(0)
    v_mfma_f32_32x32x16_bf16 v[236:251], v[220:223], v[92:95], 0
    v_mfma_f32_16x16x32_bf16 v[12:15], v[20:23], v[220:223], 0
    v_mfma_f32_32x32x16_bf16 v[44:59], v[228:231], v[92:95], 0
    v_mfma_f32_16x16x32_bf16 v[16:19], v[20:23], v[228:231], 0
    v_mfma_f32_32x32x16_bf16 v[236:251], v[224:227], v[96:99], v[236:251]
    v_mfma_f32_16x16x32_bf16 v[12:15], v[20:23], v[224:227], v[12:15]
    v_mfma_f32_32x32x16_bf16 v[44:59], v[232:235], v[96:99], v[44:59]
    v_mfma_f32_16x16x32_bf16 v[16:19], v[20:23], v[232:235], v[16:19]
K1_KVS_5:
    v_pk_add_f32 v[4:5], v[188:189], v[190:191]
    v_pk_add_f32 v[6:7], v[76:77], v[78:79]
    v_pk_add_f32 v[4:5], v[4:5], v[192:193]
    v_pk_add_f32 v[6:7], v[6:7], v[80:81]
    v_pk_add_f32 v[4:5], v[4:5], v[194:195]
    v_pk_add_f32 v[6:7], v[6:7], v[82:83]
    v_pk_add_f32 v[4:5], v[4:5], v[196:197]
    v_pk_add_f32 v[6:7], v[6:7], v[84:85]
    v_pk_add_f32 v[4:5], v[4:5], v[198:199]
    v_pk_add_f32 v[6:7], v[6:7], v[86:87]
    v_pk_add_f32 v[4:5], v[4:5], v[200:201]
    v_pk_add_f32 v[6:7], v[6:7], v[88:89]
    v_pk_add_f32 v[4:5], v[4:5], v[202:203]
    v_pk_add_f32 v[6:7], v[6:7], v[90:91]
    v_add_f32 v4, v4, v5
    v_add_f32 v6, v6, v7
    s_nop 1
    v_permlane32_swap_b32 v4, v6
    s_nop 0
    v_add_f32 v4, v4, v6
    v_rcp_f32 v4, v4
    s_nop 0
    v_mov_b32 v6, v4
    s_nop 1
    v_permlane32_swap_b32 v4, v6
    s_nop 0
    v_pk_mul_f32 v[188:189], v[188:189], v[4:5] op_sel_hi:[1,0]
    v_pk_mul_f32 v[76:77], v[76:77], v[6:7] op_sel_hi:[1,0]
    v_pk_mul_f32 v[190:191], v[190:191], v[4:5] op_sel_hi:[1,0]
    v_pk_mul_f32 v[78:79], v[78:79], v[6:7] op_sel_hi:[1,0]
    v_pk_mul_f32 v[192:193], v[192:193], v[4:5] op_sel_hi:[1,0]
    v_pk_mul_f32 v[80:81], v[80:81], v[6:7] op_sel_hi:[1,0]
    v_pk_mul_f32 v[194:195], v[194:195], v[4:5] op_sel_hi:[1,0]
    v_pk_mul_f32 v[82:83], v[82:83], v[6:7] op_sel_hi:[1,0]
    v_pk_mul_f32 v[196:197], v[196:197], v[4:5] op_sel_hi:[1,0]
    v_pk_mul_f32 v[84:85], v[84:85], v[6:7] op_sel_hi:[1,0]
    v_pk_mul_f32 v[198:199], v[198:199], v[4:5] op_sel_hi:[1,0]
    v_pk_mul_f32 v[86:87], v[86:87], v[6:7] op_sel_hi:[1,0]
    v_pk_mul_f32 v[200:201], v[200:201], v[4:5] op_sel_hi:[1,0]
    v_pk_mul_f32 v[88:89], v[88:89], v[6:7] op_sel_hi:[1,0]
    v_pk_mul_f32 v[202:203], v[202:203], v[4:5] op_sel_hi:[1,0]
    v_pk_mul_f32 v[90:91], v[90:91], v[6:7] op_sel_hi:[1,0]
    s_cmp_eq_u32 s51, 0
    s_cbranch_scc1 K1_T0_6
    v_cvt_pk_bf16_f32 v144, v188, v189
    v_cvt_pk_bf16_f32 v145, v190, v191
    v_cvt_pk_bf16_f32 v146, v192, v193
    v_cvt_pk_bf16_f32 v147, v194, v195
    v_cvt_pk_bf16_f32 v148, v196, v197
    v_cvt_pk_bf16_f32 v149, v198, v199
    v_cvt_pk_bf16_f32 v150, v200, v201
    v_cvt_pk_bf16_f32 v151, v202, v203
    v_cvt_pk_bf16_f32 v152, v76, v77
    v_cvt_pk_bf16_f32 v153, v78, v79
    v_cvt_pk_bf16_f32 v154, v80, v81
    v_cvt_pk_bf16_f32 v155, v82, v83
    v_cvt_pk_bf16_f32 v156, v84, v85
    v_cvt_pk_bf16_f32 v157, v86, v87
    v_cvt_pk_bf16_f32 v158, v88, v89
    v_cvt_pk_bf16_f32 v159, v90, v91
    s_branch K1_TJ_7
K1_T0_6:
    v_cvt_pk_bf16_f32 v204, v188, v189
    v_cvt_pk_bf16_f32 v205, v190, v191
    v_cvt_pk_bf16_f32 v206, v192, v193
    v_cvt_pk_bf16_f32 v207, v194, v195
    v_cvt_pk_bf16_f32 v208, v196, v197
    v_cvt_pk_bf16_f32 v209, v198, v199
    v_cvt_pk_bf16_f32 v210, v200, v201
    v_cvt_pk_bf16_f32 v211, v202, v203
    v_cvt_pk_bf16_f32 v212, v76, v77
    v_cvt_pk_bf16_f32 v213, v78, v79
    v_cvt_pk_bf16_f32 v214, v80, v81
    v_cvt_pk_bf16_f32 v215, v82, v83
    v_cvt_pk_bf16_f32 v216, v84, v85
    v_cvt_pk_bf16_f32 v217, v86, v87
    v_cvt_pk_bf16_f32 v218, v88, v89
    v_cvt_pk_bf16_f32 v219, v90, v91
    ds_write_b64 v24, v[204:205] offset:0
    ds_write_b64 v24, v[206:207] offset:16
    ds_write_b64 v24, v[208:209] offset:32
    ds_write_b64 v24, v[210:211] offset:48
    ds_write_b64 v24, v[212:213] offset:64
    ds_write_b64 v24, v[214:215] offset:80
    ds_write_b64 v24, v[216:217] offset:96
    ds_write_b64 v24, v[218:219] offset:112
    ds_read_b64_tr_b16 v[220:221], v25 offset:0
    ds_read_b64_tr_b16 v[222:223], v25 offset:2176
    ds_read_b64_tr_b16 v[224:225], v25 offset:544
    ds_read_b64_tr_b16 v[226:227], v25 offset:2720
    ds_read_b64_tr_b16 v[228:229], v25 offset:64
    ds_read_b64_tr_b16 v[230:231], v25 offset:2240
    ds_read_b64_tr_b16 v[232:233], v25 offset:608
    ds_read_b64_tr_b16 v[234:235], v25 offset:2784
K1_TJ_7:
    s_cmp_lg_u32 s51, 0
    s_cbranch_scc1 KF_JOIN
    s_cmp_ge_u32 s40, 4
    s_cbranch_scc1 K1_QL0
    v_pk_mul_f32 v[124:125], v[124:125], s[64:65]
    v_pk_mul_f32 v[126:127], v[126:127], s[64:65]
    v_pk_mul_f32 v[128:129], v[128:129], s[64:65]
    v_pk_mul_f32 v[130:131], v[130:131], s[64:65]
    v_pk_mul_f32 v[132:133], v[132:133], s[64:65]
    v_pk_mul_f32 v[134:135], v[134:135], s[64:65]
    v_pk_mul_f32 v[136:137], v[136:137], s[64:65]
    v_pk_mul_f32 v[138:139], v[138:139], s[64:65]
    v_cvt_pk_bf16_f32 v124, v124, v125
    v_cvt_pk_bf16_f32 v125, v126, v127
    v_cvt_pk_bf16_f32 v126, v128, v129
    v_cvt_pk_bf16_f32 v127, v130, v131
    v_cvt_pk_bf16_f32 v128, v132, v133
    v_cvt_pk_bf16_f32 v129, v134, v135
    v_cvt_pk_bf16_f32 v130, v136, v137
    v_cvt_pk_bf16_f32 v131, v138, v139
    ds_write_b128 v26, v[124:127] offset:0
    ds_write_b128 v26, v[128:131] offset:256
    v_pk_mul_f32 v[140:141], v[140:141], s[64:65]
    v_pk_mul_f32 v[142:143], v[142:143], s[64:65]
    v_pk_mul_f32 v[144:145], v[144:145], s[64:65]
    v_pk_mul_f32 v[146:147], v[146:147], s[64:65]
    v_pk_mul_f32 v[148:149], v[148:149], s[64:65]
    v_pk_mul_f32 v[150:151], v[150:151], s[64:65]
    v_pk_mul_f32 v[152:153], v[152:153], s[64:65]
    v_pk_mul_f32 v[154:155], v[154:155], s[64:65]
    v_cvt_pk_bf16_f32 v140, v140, v141
    v_cvt_pk_bf16_f32 v141, v142, v143
    v_cvt_pk_bf16_f32 v142, v144, v145
    v_cvt_pk_bf16_f32 v143, v146, v147
    v_cvt_pk_bf16_f32 v144, v148, v149
    v_cvt_pk_bf16_f32 v145, v150, v151
    v_cvt_pk_bf16_f32 v146, v152, v153
    v_cvt_pk_bf16_f32 v147, v154, v155
    ds_write_b128 v26, v[140:143] offset:2048
    ds_write_b128 v26, v[144:147] offset:2304
    v_pk_mul_f32 v[156:157], v[156:157], s[64:65]
    v_pk_mul_f32 v[158:159], v[158:159], s[64:65]
    v_pk_mul_f32 v[160:161], v[160:161], s[64:65]
    v_pk_mul_f32 v[162:163], v[162:163], s[64:65]
    v_pk_mul_f32 v[164:165], v[164:165], s[64:65]
    v_pk_mul_f32 v[166:167], v[166:167], s[64:65]
    v_pk_mul_f32 v[168:169], v[168:169], s[64:65]
    v_pk_mul_f32 v[170:171], v[170:171], s[64:65]
    v_cvt_pk_bf16_f32 v156, v156, v157
    v_cvt_pk_bf16_f32 v157, v158, v159
    v_cvt_pk_bf16_f32 v158, v160, v161
    v_cvt_pk_bf16_f32 v159, v162, v163
    v_cvt_pk_bf16_f32 v160, v164, v165
    v_cvt_pk_bf16_f32 v161, v166, v167
    v_cvt_pk_bf16_f32 v162, v168, v169
    v_cvt_pk_bf16_f32 v163, v170, v171
    ds_write_b128 v26, v[156:159] offset:4096
    ds_write_b128 v26, v[160:163] offset:4352
    v_pk_mul_f32 v[172:173], v[172:173], s[64:65]
    v_pk_mul_f32 v[174:175], v[174:175], s[64:65]
    v_pk_mul_f32 v[176:177], v[176:177], s[64:65]
    v_pk_mul_f32 v[178:179], v[178:179], s[64:65]
    v_pk_mul_f32 v[180:181], v[180:181], s[64:65]
    v_pk_mul_f32 v[182:183], v[182:183], s[64:65]
    v_pk_mul_f32 v[184:185], v[184:185], s[64:65]
    v_pk_mul_f32 v[186:187], v[186:187], s[64:65]
    v_cvt_pk_bf16_f32 v172, v172, v173
    v_cvt_pk_bf16_f32 v173, v174, v175
    v_cvt_pk_bf16_f32 v174, v176, v177
    v_cvt_pk_bf16_f32 v175, v178, v179
    v_cvt_pk_bf16_f32 v176, v180, v181
    v_cvt_pk_bf16_f32 v177, v182, v183
    v_cvt_pk_bf16_f32 v178, v184, v185
    v_cvt_pk_bf16_f32 v179, v186, v187
    ds_write_b128 v26, v[172:175] offset:6144
    ds_write_b128 v26, v[176:179] offset:6400
    s_waitcnt lgkmcnt(8)
    v_mfma_f32_32x32x16_bf16 v[236:251], v[220:223], v[100:103], v[236:251]
    v_mfma_f32_16x16x32_bf16 v[12:15], v[20:23], v[220:223], v[12:15]
    v_mfma_f32_32x32x16_bf16 v[44:59], v[228:231], v[100:103], v[44:59]
    v_mfma_f32_16x16x32_bf16 v[16:19], v[20:23], v[228:231], v[16:19]
    v_mfma_f32_32x32x16_bf16 v[236:251], v[224:227], v[104:107], v[236:251]
    v_mfma_f32_16x16x32_bf16 v[12:15], v[20:23], v[224:227], v[12:15]
    v_mfma_f32_32x32x16_bf16 v[44:59], v[232:235], v[104:107], v[44:59]
    v_mfma_f32_16x16x32_bf16 v[16:19], v[20:23], v[232:235], v[16:19]
    s_branch K1_QL1
K1_QL0:
    s_waitcnt lgkmcnt(0)
    v_mfma_f32_32x32x16_bf16 v[236:251], v[220:223], v[100:103], v[236:251]
    v_mfma_f32_16x16x32_bf16 v[12:15], v[20:23], v[220:223], v[12:15]
    v_mfma_f32_32x32x16_bf16 v[44:59], v[228:231], v[100:103], v[44:59]
    v_mfma_f32_16x16x32_bf16 v[16:19], v[20:23], v[228:231], v[16:19]
    v_mfma_f32_32x32x16_bf16 v[236:251], v[224:227], v[104:107], v[236:251]
    v_mfma_f32_16x16x32_bf16 v[12:15], v[20:23], v[224:227], v[12:15]
    v_mfma_f32_32x32x16_bf16 v[44:59], v[232:235], v[104:107], v[44:59]
    v_mfma_f32_16x16x32_bf16 v[16:19], v[20:23], v[232:235], v[16:19]
K1_QL1:
    s_cmp_ge_u32 s40, 4
    s_cselect_b32 s38, 24576, 0
    s_cselect_b32 s55, 512, 0
    s_add_u32 s38, s38, 98304
    s_add_u32 s55, s55, 114688
    s_lshl_b32 s47, s50, 13
    s_add_u32 s47, s47, s38
    v_add_u32 v2, s47, v1
    v_and_b32 v3, 31, v0
    v_lshlrev_b32 v3, 2, v3
    s_lshl_b32 s47, s50, 8
    s_add_u32 s47, s47, s55
    v_add_u32 v3, s47, v3
    s_nop 7
    ds_write_b32 v3, v12
    ds_write_b32 v3, v16 offset:128
    ds_write_b128 v2, v[236:239] offset:0
    ds_write_b128 v2, v[240:243] offset:1024
    ds_write_b128 v2, v[244:247] offset:2048
    ds_write_b128 v2, v[248:251] offset:3072
    ds_write_b128 v2, v[44:47] offset:4096
    ds_write_b128 v2, v[48:51] offset:5120
    ds_write_b128 v2, v[52:55] offset:6144
    ds_write_b128 v2, v[56:59] offset:7168
    s_branch KF_JOIN
K1_LPOST:
    s_bitcmp1_b32 s50, 0
    s_cbranch_scc0 K1_LT1
    s_mov_b32 s92, s86
    s_mov_b32 s93, s87
    s_mov_b32 s94, 256
    s_mov_b32 s95, 0x00020000
    v_mov_b32 v46, 0
    buffer_load_dword v47, v46, s[92:95], 0 offen sc1
    s_waitcnt vmcnt(5)
    s_barrier
    s_lshl_b32 s70, s42, 18
    s_add_u32 s70, s70, 4194304
    s_lshl_b32 s47, s41, 1
    s_add_u32 s47, s47, 3
    s_and_b32 s47, s47, 15
    s_lshl_b32 s47, s47, 14
    s_lshl_b32 s38, s40, 11
    s_add_u32 s71, s47, s38
    s_add_u32 s72, s38, 49152
    s_lshl_b32 s47, s41, 3
    s_add_u32 s47, s47, s40
    s_lshl_b32 s47, s47, 5
    s_add_u32 s47, s47, s42
    s_lshl_b32 s73, s47, 11
    s_add_u32 s73, s73, 29360128
    s_lshr_b32 s39, s40, 1
    s_and_b32 s39, s39, 1
    s_lshl_b32 s47, s41, 3
    s_lshl_b32 s38, s39, 2
    s_add_u32 s47, s47, s38
    s_lshl_b32 s47, s47, 5
    s_add_u32 s47, s47, s42
    s_lshl_b32 s74, s47, 11
    s_add_u32 s74, s74, 25165824
    s_lshl_b32 s75, s42, 16
    s_lshl_b32 s47, s40, 10
    s_add_u32 s75, s75, s47
    s_add_u32 s75, s75, 20971520
    s_lshl_b32 s47, s41, 13
    s_add_u32 s79, s75, s47
    s_lshl_b32 s76, s42, 11
    s_add_u32 s76, s76, 23068672
    s_lshl_b32 s47, s41, 8
    s_add_u32 s89, s76, s47
    s_lshl_b32 s77, s42, 8
    s_add_u32 s77, s77, 24121344
    s_lshl_b32 s47, s41, 5
    s_add_u32 s68, s77, s47
    s_lshl_b32 s47, s40, 2
    s_add_u32 s68, s68, s47
    s_lshl_b32 s78, s42, 6
    s_add_u32 s78, s78, 24117248
    s_lshl_b32 s47, s41, 3
    s_add_u32 s67, s78, s47
    s_lshl_b32 s38, s39, 2
    s_add_u32 s67, s67, s38
    s_lshl_b32 s88, s41, 8
    s_lshl_b32 s47, s42, 3
    s_add_u32 s88, s88, s47
    s_add_u32 s88, s88, s38
    s_add_u32 s88, s88, 24133632
    s_lshl_b32 s47, s41, 1
    s_lshr_b32 s38, s40, 2
    s_add_u32 s47, s47, s38
    s_lshl_b32 s69, s47, 9
    s_lshl_b32 s47, s42, 4
    s_add_u32 s69, s69, s47
    s_and_b32 s47, s40, 3
    s_lshl_b32 s47, s47, 2
    s_add_u32 s69, s69, s47
    s_add_u32 s69, s69, 24137728
    s_add_u32 s74, s74, 131072
    s_waitcnt vmcnt(1)
    s_barrier
    s_branch K1_LT2
K1_LT1:
    s_mov_b32 s36, s12
    s_mov_b32 s37, s13
    s_mov_b32 s38, 2048
    s_mov_b32 s39, 0x00020000
    s_lshl_b32 s47, s41, 8
    s_lshl_b32 s51, s42, 3
    s_add_u32 s47, s47, s51
    s_lshl_b32 s51, s50, 1
    s_and_b32 s51, s51, 4
    s_add_u32 s63, s47, s51
    s_lshl_b32 s51, s63, 11
    v_lshlrev_b32 v1, 5, v0
    buffer_load_dwordx4 v[160:163], v1, s[36:39], 0 offen
    buffer_load_dwordx4 v[164:167], v1, s[36:39], 0 offen offset:16
    buffer_load_dwordx4 v[168:171], v1, s[16:19], s51 offen
    buffer_load_dwordx4 v[172:175], v1, s[16:19], s51 offen offset:16
    s_add_u32 s51, s51, 2048
    buffer_load_dwordx4 v[176:179], v1, s[16:19], s51 offen
    buffer_load_dwordx4 v[180:183], v1, s[16:19], s51 offen offset:16
    s_add_u32 s51, s51, 2048
    buffer_load_dwordx4 v[184:187], v1, s[16:19], s51 offen
    buffer_load_dwordx4 v[188:191], v1, s[16:19], s51 offen offset:16
    s_add_u32 s51, s51, 2048
    buffer_load_dwordx4 v[192:195], v1, s[16:19], s51 offen
    buffer_load_dwordx4 v[196:199], v1, s[16:19], s51 offen offset:16
    s_mov_b32 s84, s63
    s_mov_b32 s92, s86
    s_mov_b32 s93, s87
    s_mov_b32 s94, 256
    s_mov_b32 s95, 0x00020000
    v_mov_b32 v46, 0
    buffer_load_dword v47, v46, s[92:95], 0 offen sc1
    s_waitcnt vmcnt(15)
    s_barrier
    s_lshl_b32 s70, s42, 18
    s_add_u32 s70, s70, 4194304
    s_lshl_b32 s47, s41, 1
    s_add_u32 s47, s47, 3
    s_and_b32 s47, s47, 15
    s_lshl_b32 s47, s47, 14
    s_lshl_b32 s38, s40, 11
    s_add_u32 s71, s47, s38
    s_add_u32 s72, s38, 49152
    s_lshl_b32 s47, s41, 3
    s_add_u32 s47, s47, s40
    s_lshl_b32 s47, s47, 5
    s_add_u32 s47, s47, s42
    s_lshl_b32 s73, s47, 11
    s_add_u32 s73, s73, 29360128
    s_lshr_b32 s39, s40, 1
    s_and_b32 s39, s39, 1
    s_lshl_b32 s47, s41, 3
    s_lshl_b32 s38, s39, 2
    s_add_u32 s47, s47, s38
    s_lshl_b32 s47, s47, 5
    s_add_u32 s47, s47, s42
    s_lshl_b32 s74, s47, 11
    s_add_u32 s74, s74, 25165824
    s_lshl_b32 s75, s42, 16
    s_lshl_b32 s47, s40, 10
    s_add_u32 s75, s75, s47
    s_add_u32 s75, s75, 20971520
    s_lshl_b32 s47, s41, 13
    s_add_u32 s79, s75, s47
    s_lshl_b32 s76, s42, 11
    s_add_u32 s76, s76, 23068672
    s_lshl_b32 s47, s41, 8
    s_add_u32 s89, s76, s47
    s_lshl_b32 s77, s42, 8
    s_add_u32 s77, s77, 24121344
    s_lshl_b32 s47, s41, 5
    s_add_u32 s68, s77, s47
    s_lshl_b32 s47, s40, 2
    s_add_u32 s68, s68, s47
    s_lshl_b32 s78, s42, 6
    s_add_u32 s78, s78, 24117248
    s_lshl_b32 s47, s41, 3
    s_add_u32 s67, s78, s47
    s_lshl_b32 s38, s39, 2
    s_add_u32 s67, s67, s38
    s_lshl_b32 s88, s41, 8
    s_lshl_b32 s47, s42, 3
    s_add_u32 s88, s88, s47
    s_add_u32 s88, s88, s38
    s_add_u32 s88, s88, 24133632
    s_lshl_b32 s47, s41, 1
    s_lshr_b32 s38, s40, 2
    s_add_u32 s47, s47, s38
    s_lshl_b32 s69, s47, 9
    s_lshl_b32 s47, s42, 4
    s_add_u32 s69, s69, s47
    s_and_b32 s47, s40, 3
    s_lshl_b32 s47, s47, 2
    s_add_u32 s69, s69, s47
    s_add_u32 s69, s69, 24137728
    s_add_u32 s74, s74, 131072
    s_waitcnt vmcnt(11)
    s_barrier
K1_LT2:
    s_setprio 0
    s_load_dwordx2 s[4:5], s[0:1], 24
    s_load_dwordx2 s[6:7], s[0:1], 48
    s_load_dwordx2 s[8:9], s[0:1], 64
    s_lshr_b32 s16, s45, 1
    s_lshl_b32 s16, s16, 2
    s_lshr_b32 s47, s46, 3
    s_add_u32 s16, s16, s47
    s_and_b32 s17, s45, 1
    s_lshl_b32 s17, s17, 3
    s_and_b32 s47, s46, 7
    s_add_u32 s17, s17, s47
    s_lshr_b32 s18, s40, 2
    s_and_b32 s19, s40, 3
    s_lshl_b32 s47, s16, 2
    s_add_u32 s47, s47, s19
    s_lshl_b32 s28, s47, 16
    s_lshl_b32 s38, s18, 15
    s_add_u32 s28, s28, s38
    s_add_u32 s28, s28, 25165824
    s_lshl_b32 s31, s47, 7
    s_add_u32 s31, s31, 23134208
    s_lshr_b32 s47, s16, 1
    s_lshl_b32 s36, s47, 8
    s_add_u32 s36, s36, 24133632
    s_lshl_b32 s83, s16, 9
    s_add_u32 s83, s83, 24137728
    s_lshl_b32 s30, s18, 13
    s_lshl_b32 s38, s19, 11
    s_add_u32 s30, s30, s38
    s_mov_b32 s29, 0
    s_waitcnt lgkmcnt(0)
    s_mov_b32 s20, s4
    s_mov_b32 s21, s5
    s_mov_b32 s22, 2097152
    s_mov_b32 s23, 0x00020000
    s_barrier
    s_and_b32 s51, s50, 1
    s_xor_b32 s51, s51, 1
    s_lshr_b32 s50, s50, 1
    v_lshrrev_b32 v5, 5, v0
    v_bfe_u32 v6, v0, 2, 2
    v_lshl_add_u32 v6, v5, 3, v6
    v_bfe_u32 v7, v0, 4, 1
    v_lshlrev_b32 v7, 5, v7
    v_and_b32 v8, 3, v0
    v_lshl_add_u32 v7, v8, 3, v7
    v_lshl_add_u32 v2, v6, 6, v7
    v_add_u32 v2, 159744, v2
    ds_read_b64_tr_b16 v[36:37], v2 offset:0
    ds_read_b64_tr_b16 v[38:39], v2 offset:1024
    ds_read_b64_tr_b16 v[40:41], v2 offset:256
    ds_read_b64_tr_b16 v[42:43], v2 offset:1280
    s_mul_i32 s47, s50, 4352
    s_add_u32 s47, s47, 147456
    v_mul_u32_u24 v25, 136, v6
    v_add_u32 v25, v25, v7
    v_add_u32 v25, s47, v25
    v_and_b32 v8, 31, v0
    v_mul_u32_u24 v24, 136, v8
    v_lshl_add_u32 v24, v5, 3, v24
    v_add_u32 v24, s47, v24
    v_bfe_u32 v8, v0, 2, 1
    v_bfe_u32 v9, v0, 4, 1
    v_cmp_eq_u32 vcc, v8, v9
    v_mov_b32 v9, 0x3f803f80
    v_mov_b32 v8, 0
    v_cndmask_b32 v20, v8, v9, vcc
    v_cndmask_b32 v21, v8, v9, vcc
    v_cndmask_b32 v22, v8, v9, vcc
    v_cndmask_b32 v23, v8, v9, vcc
    v_lshlrev_b32 v1, 4, v0
    s_lshl_b32 s47, s50, 13
    s_add_u32 s47, s47, 122880
    s_lshl_b32 s38, s50, 12
    s_add_u32 s38, s38, 139264
    s_cmp_eq_u32 s51, 0
    s_cselect_b32 s47, s47, s38
    v_add_u32 v45, s47, v1
    v_mov_b32 v200, 0
    v_mov_b32 v201, 0
    v_mov_b32 v202, 0
    v_mov_b32 v203, 0
    s_barrier
    s_waitcnt vmcnt(0)
    v_cmp_eq_u32 vcc, 0x100, v47
    s_cmp_eq_u64 vcc, -1
    s_cbranch_scc1 PG_OK_8
    s_mov_b32 s82, 0
PG_SP_9:
    s_sleep 2
    buffer_load_dword v47, v46, s[92:95], 0 offen sc1
    s_add_u32 s82, s82, 1
    s_waitcnt vmcnt(0)
    v_cmp_eq_u32 vcc, 0x100, v47
    s_cmp_eq_u64 vcc, -1
    s_cbranch_scc1 PG_OK_8
    s_cmp_lt_u32 s82, 65536
    s_cbranch_scc1 PG_SP_9
PG_OK_8:
    s_barrier
    ds_read_b128 v[108:111], v45 offset:0
    ds_read_b128 v[112:115], v45 offset:1024
    ds_read_b128 v[116:119], v45 offset:2048
    ds_read_b128 v[120:123], v45 offset:3072
    s_cmp_lg_u32 s51, 0
    s_cbranch_scc1 K1_LNV
    ds_read_b128 v[92:95], v45 offset:4096
    ds_read_b128 v[96:99], v45 offset:5120
    ds_read_b128 v[100:103], v45 offset:6144
    ds_read_b128 v[104:107], v45 offset:7168
    s_branch K1_E2L
K1_LNV:
    v_dot2c_f32_bf16 v200, v168, v160
    v_dot2c_f32_bf16 v201, v176, v160
    v_dot2c_f32_bf16 v202, v184, v160
    v_dot2c_f32_bf16 v203, v192, v160
    v_dot2c_f32_bf16 v200, v169, v161
    v_dot2c_f32_bf16 v201, v177, v161
    v_dot2c_f32_bf16 v202, v185, v161
    v_dot2c_f32_bf16 v203, v193, v161
    v_dot2c_f32_bf16 v200, v170, v162
    v_dot2c_f32_bf16 v201, v178, v162
    v_dot2c_f32_bf16 v202, v186, v162
    v_dot2c_f32_bf16 v203, v194, v162
    v_dot2c_f32_bf16 v200, v171, v163
    v_dot2c_f32_bf16 v201, v179, v163
    v_dot2c_f32_bf16 v202, v187, v163
    v_dot2c_f32_bf16 v203, v195, v163
    v_dot2c_f32_bf16 v200, v172, v164
    v_dot2c_f32_bf16 v201, v180, v164
    v_dot2c_f32_bf16 v202, v188, v164
    v_dot2c_f32_bf16 v203, v196, v164
    v_dot2c_f32_bf16 v200, v173, v165
    v_dot2c_f32_bf16 v201, v181, v165
    v_dot2c_f32_bf16 v202, v189, v165
    v_dot2c_f32_bf16 v203, v197, v165
    v_dot2c_f32_bf16 v200, v174, v166
    v_dot2c_f32_bf16 v201, v182, v166
    v_dot2c_f32_bf16 v202, v190, v166
    v_dot2c_f32_bf16 v203, v198, v166
    v_dot2c_f32_bf16 v200, v175, v167
    v_dot2c_f32_bf16 v201, v183, v167
    v_dot2c_f32_bf16 v202, v191, v167
    v_dot2c_f32_bf16 v203, v199, v167
    s_nop 2
    v_add_f32_dpp v200, v200, v200 row_ror:8 row_mask:0xf bank_mask:0xf
    v_add_f32_dpp v201, v201, v201 row_ror:8 row_mask:0xf bank_mask:0xf
    v_add_f32_dpp v202, v202, v202 row_ror:8 row_mask:0xf bank_mask:0xf
    v_add_f32_dpp v203, v203, v203 row_ror:8 row_mask:0xf bank_mask:0xf
    v_add_f32_dpp v200, v200, v200 row_ror:4 row_mask:0xf bank_mask:0xf
    v_add_f32_dpp v201, v201, v201 row_ror:4 row_mask:0xf bank_mask:0xf
    v_add_f32_dpp v202, v202, v202 row_ror:4 row_mask:0xf bank_mask:0xf
    v_add_f32_dpp v203, v203, v203 row_ror:4 row_mask:0xf bank_mask:0xf
    v_add_f32_dpp v200, v200, v200 row_ror:2 row_mask:0xf bank_mask:0xf
    v_add_f32_dpp v201, v201, v201 row_ror:2 row_mask:0xf bank_mask:0xf
    v_add_f32_dpp v202, v202, v202 row_ror:2 row_mask:0xf bank_mask:0xf
    v_add_f32_dpp v203, v203, v203 row_ror:2 row_mask:0xf bank_mask:0xf
    v_add_f32_dpp v200, v200, v200 row_ror:1 row_mask:0xf bank_mask:0xf
    v_add_f32_dpp v201, v201, v201 row_ror:1 row_mask:0xf bank_mask:0xf
    v_add_f32_dpp v202, v202, v202 row_ror:1 row_mask:0xf bank_mask:0xf
    v_add_f32_dpp v203, v203, v203 row_ror:1 row_mask:0xf bank_mask:0xf
    v_permlane16_swap_b32 v200, v201
    s_nop 0
    v_permlane16_swap_b32 v202, v203
    s_nop 1
    v_add_f32 v200, v200, v201
    v_add_f32 v201, v202, v203
    s_nop 1
    v_permlane32_swap_b32 v200, v201
    s_nop 1
    v_add_f32 v200, v200, v201
    v_mul_f32 v200, 0xbfb8aa3b, v200
    v_exp_f32 v200, v200
    v_lshrrev_b32 v202, 4, v0
    v_lshlrev_b32 v202, 2, v202
    v_add_f32 v200, 1.0, v200
    v_rcp_f32 v200, v200
    s_lshl_b32 s47, s84, 2
    s_add_u32 s47, s47, 23134208
    s_mov_b32 exec_lo, 0x10001
    s_mov_b32 exec_hi, 0x10001
    buffer_store_dword v200, v202, s[32:35], s47 offen sc1
    s_mov_b64 exec, -1
    s_branch K1_E2L
KF_JOIN:
    s_setprio 0
    v_lshlrev_b32 v3, 4, v0
    s_lshl_b32 s47, s40, 11
    s_add_u32 s47, s47, 65536
    v_add_u32 v6, s47, v3
    s_lshl_b32 s47, s40, 10
    s_add_u32 s47, s47, 98304
    v_add_u32 v7, s47, v3
    v_and_b32 v46, 15, v0
    v_lshlrev_b32 v46, 2, v46
    buffer_load_dword v47, v46, s[32:35], s78 offen sc1
    s_mov_b32 s60, 0
    s_mov_b32 s61, 1
    s_waitcnt lgkmcnt(0)
    s_barrier
    ds_read_b128 v[8:11], v6
    ds_read_b128 v[48:51], v3
    ds_read_b128 v[12:15], v6 offset:1024
    ds_read_b128 v[52:55], v3 offset:1024
    ds_read_b128 v[16:19], v3 offset:4096
    ds_read_b128 v[20:23], v3 offset:5120
    ds_read_b128 v[24:27], v3 offset:2048
    ds_read_b128 v[192:195], v7
    ds_read_b128 v[196:199], v7 offset:8192
    ds_read_b128 v[204:207], v7 offset:24576
    ds_read_b128 v[208:211], v7 offset:32768
    v_mov_b32 v96, 0
    v_mov_b32 v97, 0
    v_mov_b32 v98, 0
    v_mov_b32 v99, 0
    v_mov_b32 v100, 0
    v_mov_b32 v101, 0
    v_mov_b32 v102, 0
    v_mov_b32 v103, 0
    v_mov_b32 v104, 0
    v_mov_b32 v105, 0
    v_mov_b32 v106, 0
    v_mov_b32 v107, 0
    v_mov_b32 v108, 0
    v_mov_b32 v109, 0
    v_mov_b32 v110, 0
    v_mov_b32 v111, 0
    v_mov_b32 v112, 0
    v_mov_b32 v28, 0
    v_mov_b32 v124, 0
    v_mov_b32 v113, 0
    s_waitcnt lgkmcnt(9)
    v_mfma_f32_32x32x16_bf16 v[64:79], v[48:51], v[8:11], 0
    s_waitcnt lgkmcnt(7)
    v_mfma_f32_32x32x16_bf16 v[64:79], v[52:55], v[12:15], v[64:79]
    v_bfe_u32 v4, v0, 2, 1
    v_bfe_u32 v5, v0, 4, 1
    v_cmp_eq_u32 vcc, v4, v5
    v_mov_b32 v5, 0x3f803f80
    v_mov_b32 v4, 0
    v_cndmask_b32 v40, v4, v5, vcc
    v_cndmask_b32 v41, v4, v5, vcc
    v_cndmask_b32 v42, v4, v5, vcc
    v_cndmask_b32 v43, v4, v5, vcc
    v_mov_b32 v1, v3
    v_add_u32 v2, 16384, v3
    v_mov_b32 v29, 0
    v_mov_b32 v125, 0
    v_mov_b32 v114, 0
    v_mov_b32 v30, 0
    v_mov_b32 v126, 0
    v_mov_b32 v115, 0
    v_mov_b32 v31, 0
    v_mov_b32 v127, 0
    v_mov_b32 v35, 0
    v_mov_b32 v36, 0
    v_mov_b32 v37, 0
    v_mov_b32 v38, 0
    v_mov_b32 v39, 0
    v_mov_b32 v45, 0
    s_nop 5
    v_max3_f32 v4, v64, v65, v66
    v_max3_f32 v5, v67, v68, v69
    v_max3_f32 v4, v4, v70, v71
    v_max3_f32 v5, v5, v72, v73
    v_max3_f32 v4, v4, v74, v75
    v_max3_f32 v5, v5, v76, v77
    v_max3_f32 v4, v4, v78, v79
    v_max_f32 v4, v4, v5
    v_mov_b32 v5, v4
    s_nop 1
    v_permlane32_swap_b32 v4, v5
    s_nop 0
    v_max_f32 v4, v4, v5
    v_add_f32 v4, 0x42a00000, v4
    v_sub_f32 v48, 0, v4
    v_sub_f32 v49, 0, v4
    v_pk_mov_b32 v[50:51], v[48:49], v[48:49] op_sel:[0,1]
    v_pk_mov_b32 v[52:53], v[48:49], v[48:49] op_sel:[0,1]
    v_pk_mov_b32 v[54:55], v[48:49], v[48:49] op_sel:[0,1]
    v_pk_mov_b32 v[56:57], v[48:49], v[48:49] op_sel:[0,1]
    v_pk_mov_b32 v[58:59], v[48:49], v[48:49] op_sel:[0,1]
    v_pk_mov_b32 v[60:61], v[48:49], v[48:49] op_sel:[0,1]
    v_pk_mov_b32 v[62:63], v[48:49], v[48:49] op_sel:[0,1]
    v_pk_add_f32 v[64:65], v[64:65], v[48:49]
    v_pk_add_f32 v[66:67], v[66:67], v[48:49]
    v_pk_add_f32 v[68:69], v[68:69], v[48:49]
    v_pk_add_f32 v[70:71], v[70:71], v[48:49]
    v_pk_add_f32 v[72:73], v[72:73], v[48:49]
    v_pk_add_f32 v[74:75], v[74:75], v[48:49]
    v_pk_add_f32 v[76:77], v[76:77], v[48:49]
    v_pk_add_f32 v[78:79], v[78:79], v[48:49]
    s_waitcnt lgkmcnt(0)
    v_pk_add_f32 v[192:193], v[192:193], v[196:197]
    v_pk_add_f32 v[194:195], v[194:195], v[198:199]
    v_pk_add_f32 v[204:205], v[204:205], v[208:209]
    v_pk_add_f32 v[206:207], v[206:207], v[210:211]
    v_pk_add_f32 v[192:193], v[192:193], v[204:205]
    v_pk_add_f32 v[194:195], v[194:195], v[206:207]
    s_cmp_lg_u32 s40, 7
    s_cbranch_scc1 KJ_NOZ
    v_lshlrev_b32 v4, 2, v0
    v_add_u32 v5, 114688, v4
    ds_read_b32 v200, v5
    ds_read_b32 v201, v5 offset:256
    ds_read_b32 v202, v5 offset:512
    ds_read_b32 v203, v5 offset:768
    s_waitcnt lgkmcnt(0)
    v_add_f32 v200, v200, v201
    v_add_f32 v202, v202, v203
    v_add_f32 v200, v200, v202
KJ_NOZ:
    s_waitcnt vmcnt(0)
    v_cmp_eq_u32 vcc, 1, v47
    s_cmp_eq_u64 vcc, -1
    s_cbranch_scc1 P1_OK_10
    s_mov_b32 s82, 0
P1_SP_11:
    s_sleep 2
    buffer_load_dword v47, v46, s[32:35], s78 offen sc1
    s_add_u32 s82, s82, 1
    s_waitcnt vmcnt(0)
    v_cmp_eq_u32 vcc, 1, v47
    s_cmp_eq_u64 vcc, -1
    s_cbranch_scc1 P1_OK_10
    s_cmp_lt_u32 s82, 65536
    s_cbranch_scc1 P1_SP_11
P1_OK_10:
    buffer_store_dwordx4 v[192:195], v3, s[32:35], s79 offen sc1
    s_cmp_lg_u32 s40, 7
    s_cbranch_scc1 KJ_NOZ2
    v_lshlrev_b32 v4, 2, v0
    buffer_store_dword v200, v4, s[32:35], s89 offen sc1
KJ_NOZ2:
    s_lshl_b32 s47, s40, 11
    s_add_u32 m0, s47, 32768
    s_lshl_b32 s38, s41, 1
    s_add_u32 s38, s38, 2
    s_and_b32 s38, s38, 15
    s_lshl_b32 s38, s38, 14
    s_add_u32 s38, s38, s47
    s_add_u32 s81, s38, s70
    buffer_load_dwordx4 v3, s[32:35], s81 offen sc1 lds
    buffer_load_dwordx4 v3, s[32:35], s81 offen offset:1024 sc1 lds
K2_LOOP:
    s_mov_b32 m0, s72
    s_add_u32 s81, s70, s71
    s_add_u32 s72, s72, 16384
    buffer_load_dwordx4 v3, s[32:35], s81 offen sc1 lds
    buffer_load_dwordx4 v3, s[32:35], s81 offen offset:1024 sc1 lds
    s_and_b32 s72, s72, 65535
    s_add_u32 s71, s71, 16384
    s_and_b32 s71, s71, 0x3ffff
    s_setprio 3
    v_exp_f32 v64, v64
    v_exp_f32 v65, v65
    s_waitcnt lgkmcnt(3)
    v_mfma_f32_32x32x16_bf16 v[96:111], v[28:31], v[124:127], v[96:111]
    ds_read_b128 v[28:31], v1 offset:3072
    v_exp_f32 v66, v66
    v_exp_f32 v67, v67
    v_exp_f32 v68, v68
    v_exp_f32 v69, v69
    s_waitcnt lgkmcnt(3)
    v_mfma_f32_32x32x16_bf16 v[80:95], v[16:19], v[8:11], v[48:63]
    ds_read_b128 v[16:19], v1 offset:8192
    v_exp_f32 v70, v70
    v_exp_f32 v71, v71
    v_cvt_pk_bf16_f32 v120, v64, v65
    v_cvt_pk_bf16_f32 v121, v66, v67
    v_mfma_f32_16x16x32_bf16 v[112:115], v[40:43], v[124:127], v[112:115]
    v_cvt_pk_bf16_f32 v122, v68, v69
    v_cvt_pk_bf16_f32 v123, v70, v71
    v_exp_f32 v72, v72
    s_waitcnt lgkmcnt(3)
    v_mfma_f32_32x32x16_bf16 v[80:95], v[20:23], v[12:15], v[80:95]
    ds_read_b128 v[20:23], v1 offset:9216
    v_exp_f32 v73, v73
    v_exp_f32 v74, v74
    v_exp_f32 v75, v75
    s_waitcnt lgkmcnt(3)
    v_mfma_f32_32x32x16_bf16 v[96:111], v[24:27], v[120:123], v[96:111]
    ds_read_b128 v[24:27], v1 offset:6144
    v_exp_f32 v76, v76
    v_exp_f32 v77, v77
    v_exp_f32 v78, v78
    v_mfma_f32_16x16x32_bf16 v[112:115], v[40:43], v[120:123], v[112:115]
    v_exp_f32 v79, v79
    v_cvt_pk_bf16_f32 v124, v72, v73
    v_cvt_pk_bf16_f32 v125, v74, v75
    v_cvt_pk_bf16_f32 v126, v76, v77
    v_cvt_pk_bf16_f32 v127, v78, v79
    s_setprio 2
    v_exp_f32 v80, v80
    v_exp_f32 v81, v81
    s_waitcnt lgkmcnt(3)
    v_mfma_f32_32x32x16_bf16 v[96:111], v[28:31], v[124:127], v[96:111]
    ds_read_b128 v[28:31], v1 offset:7168
    v_exp_f32 v82, v82
    v_exp_f32 v83, v83
    v_exp_f32 v84, v84
    v_exp_f32 v85, v85
    s_waitcnt lgkmcnt(3)
    v_mfma_f32_32x32x16_bf16 v[64:79], v[16:19], v[8:11], v[48:63]
    ds_read_b128 v[16:19], v1 offset:12288
    v_exp_f32 v86, v86
    v_exp_f32 v87, v87
    v_cvt_pk_bf16_f32 v120, v80, v81
    v_cvt_pk_bf16_f32 v121, v82, v83
    v_mfma_f32_16x16x32_bf16 v[112:115], v[40:43], v[124:127], v[112:115]
    v_cvt_pk_bf16_f32 v122, v84, v85
    v_cvt_pk_bf16_f32 v123, v86, v87
    v_exp_f32 v88, v88
    s_waitcnt lgkmcnt(3)
    v_mfma_f32_32x32x16_bf16 v[64:79], v[20:23], v[12:15], v[64:79]
    ds_read_b128 v[20:23], v1 offset:13312
    v_exp_f32 v89, v89
    v_exp_f32 v90, v90
    v_exp_f32 v91, v91
    s_waitcnt lgkmcnt(3)
    v_mfma_f32_32x32x16_bf16 v[96:111], v[24:27], v[120:123], v[96:111]
    ds_read_b128 v[24:27], v1 offset:10240
    v_exp_f32 v92, v92
    v_exp_f32 v93, v93
    v_exp_f32 v94, v94
    v_mfma_f32_16x16x32_bf16 v[112:115], v[40:43], v[120:123], v[112:115]
    v_exp_f32 v95, v95
    v_cvt_pk_bf16_f32 v124, v88, v89
    v_cvt_pk_bf16_f32 v125, v90, v91
    v_cvt_pk_bf16_f32 v126, v92, v93
    v_cvt_pk_bf16_f32 v127, v94, v95
    s_setprio 1
    v_exp_f32 v64, v64
    v_exp_f32 v65, v65
    s_waitcnt lgkmcnt(3)
    v_mfma_f32_32x32x16_bf16 v[96:111], v[28:31], v[124:127], v[96:111]
    ds_read_b128 v[28:31], v1 offset:11264
    v_exp_f32 v66, v66
    v_exp_f32 v67, v67
    v_exp_f32 v68, v68
    v_exp_f32 v69, v69
    s_waitcnt lgkmcnt(3)
    v_mfma_f32_32x32x16_bf16 v[80:95], v[16:19], v[8:11], v[48:63]
    ds_read_b128 v[16:19], v2 offset:0
    v_exp_f32 v70, v70
    v_exp_f32 v71, v71
    v_cvt_pk_bf16_f32 v120, v64, v65
    v_cvt_pk_bf16_f32 v121, v66, v67
    v_mfma_f32_16x16x32_bf16 v[112:115], v[40:43], v[124:127], v[112:115]
    v_cvt_pk_bf16_f32 v122, v68, v69
    v_cvt_pk_bf16_f32 v123, v70, v71
    v_exp_f32 v72, v72
    s_waitcnt lgkmcnt(3)
    v_mfma_f32_32x32x16_bf16 v[80:95], v[20:23], v[12:15], v[80:95]
    ds_read_b128 v[20:23], v2 offset:1024
    v_exp_f32 v73, v73
    v_exp_f32 v74, v74
    v_exp_f32 v75, v75
    s_waitcnt lgkmcnt(3)
    v_mfma_f32_32x32x16_bf16 v[96:111], v[24:27], v[120:123], v[96:111]
    ds_read_b128 v[24:27], v1 offset:14336
    v_exp_f32 v76, v76
    v_exp_f32 v77, v77
    v_exp_f32 v78, v78
    v_mfma_f32_16x16x32_bf16 v[112:115], v[40:43], v[120:123], v[112:115]
    v_exp_f32 v79, v79
    v_cvt_pk_bf16_f32 v124, v72, v73
    v_cvt_pk_bf16_f32 v125, v74, v75
    v_cvt_pk_bf16_f32 v126, v76, v77
    v_cvt_pk_bf16_f32 v127, v78, v79
    s_setprio 0
    v_exp_f32 v80, v80
    v_exp_f32 v81, v81
    s_waitcnt lgkmcnt(3)
    v_mfma_f32_32x32x16_bf16 v[96:111], v[28:31], v[124:127], v[96:111]
    ds_read_b128 v[28:31], v1 offset:15360
    v_exp_f32 v82, v82
    v_exp_f32 v83, v83
    v_exp_f32 v84, v84
    v_exp_f32 v85, v85
    s_waitcnt lgkmcnt(3)
    v_mfma_f32_32x32x16_bf16 v[64:79], v[16:19], v[8:11], v[48:63]
    ds_read_b128 v[16:19], v2 offset:4096
    v_exp_f32 v86, v86
    v_exp_f32 v87, v87
    v_cvt_pk_bf16_f32 v120, v80, v81
    v_cvt_pk_bf16_f32 v121, v82, v83
    v_mfma_f32_16x16x32_bf16 v[112:115], v[40:43], v[124:127], v[112:115]
    v_cvt_pk_bf16_f32 v122, v84, v85
    v_cvt_pk_bf16_f32 v123, v86, v87
    v_exp_f32 v88, v88
    s_waitcnt lgkmcnt(3)
    v_mfma_f32_32x32x16_bf16 v[64:79], v[20:23], v[12:15], v[64:79]
    ds_read_b128 v[20:23], v2 offset:5120
    v_exp_f32 v89, v89
    v_exp_f32 v90, v90
    v_exp_f32 v91, v91
    s_waitcnt lgkmcnt(3)
    v_mfma_f32_32x32x16_bf16 v[96:111], v[24:27], v[120:123], v[96:111]
    ds_read_b128 v[24:27], v2 offset:2048
    v_exp_f32 v92, v92
    v_exp_f32 v93, v93
    v_exp_f32 v94, v94
    v_mfma_f32_16x16x32_bf16 v[112:115], v[40:43], v[120:123], v[112:115]
    v_exp_f32 v95, v95
    v_cvt_pk_bf16_f32 v124, v88, v89
    v_cvt_pk_bf16_f32 v125, v90, v91
    v_cvt_pk_bf16_f32 v126, v92, v93
    v_cvt_pk_bf16_f32 v127, v94, v95
    v_mov_b32 v1, v2
    v_add_u32 v2, 16384, v2
    v_and_b32 v2, 65535, v2
    s_add_u32 s60, s60, 1
    s_cmp_lg_u32 s60, s61
    s_waitcnt vmcnt(2)
    s_barrier
    s_cbranch_scc1 K2_LOOP
    s_cmp_eq_u32 s60, 1
    s_cbranch_scc1 KD_1
    s_cmp_eq_u32 s60, 3
    s_cbranch_scc1 KD_3
    s_cmp_eq_u32 s60, 4
    s_cbranch_scc1 KD_4
    s_branch KD_7
KD_1:
    s_mov_b32 s61, 3
    s_mov_b64 exec, 1
    v_mov_b32 v4, 1
    v_mov_b32 v5, 0
    buffer_store_dword v4, v5, s[32:35], s68 offen sc1
    s_mov_b64 exec, -1
    s_branch K2_LOOP
KD_3:
    v_lshlrev_b32 v46, 2, v0
    s_mov_b32 s61, 4
    buffer_load_dword v47, v46, s[32:35], s77 offen sc1
    s_branch K2_LOOP
KD_4:
    v_cmp_eq_u32 vcc, 1, v47
    s_cmp_eq_u64 vcc, -1
    s_cbranch_scc1 PK_OK_12
    s_mov_b32 s82, 0
PK_SP_13:
    s_sleep 2
    buffer_load_dword v47, v46, s[32:35], s77 offen sc1
    s_add_u32 s82, s82, 1
    s_waitcnt vmcnt(0)
    v_cmp_eq_u32 vcc, 1, v47
    s_cmp_eq_u64 vcc, -1
    s_cbranch_scc1 PK_OK_12
    s_cmp_lt_u32 s82, 65536
    s_cbranch_scc1 PK_SP_13
PK_OK_12:
    s_cmp_eq_u32 s40, 4
    s_cselect_b32 s84, 1, 0
    s_mov_b32 m0, s72
    s_add_u32 s81, s70, s71
    s_add_u32 s72, s72, 16384
    buffer_load_dwordx4 v3, s[32:35], s81 offen sc1 lds
    buffer_load_dwordx4 v3, s[32:35], s81 offen offset:1024 sc1 lds
    s_and_b32 s72, s72, 65535
    s_add_u32 s71, s71, 16384
    s_and_b32 s71, s71, 0x3ffff
    s_setprio 3
    v_exp_f32 v64, v64
    v_exp_f32 v65, v65
    s_waitcnt lgkmcnt(3)
    v_mfma_f32_32x32x16_bf16 v[96:111], v[28:31], v[124:127], v[96:111]
    ds_read_b128 v[28:31], v1 offset:3072
    buffer_load_dwordx4 v[192:195], v3, s[32:35], s75 offen sc1
    s_add_u32 s75, s75, 8192
    v_exp_f32 v66, v66
    v_exp_f32 v67, v67
    v_exp_f32 v68, v68
    v_exp_f32 v69, v69
    s_waitcnt lgkmcnt(3)
    v_mfma_f32_32x32x16_bf16 v[80:95], v[16:19], v[8:11], v[48:63]
    ds_read_b128 v[16:19], v1 offset:8192
    v_exp_f32 v70, v70
    v_exp_f32 v71, v71
    v_cvt_pk_bf16_f32 v120, v64, v65
    v_cvt_pk_bf16_f32 v121, v66, v67
    v_mfma_f32_16x16x32_bf16 v[112:115], v[40:43], v[124:127], v[112:115]
    v_cvt_pk_bf16_f32 v122, v68, v69
    v_cvt_pk_bf16_f32 v123, v70, v71
    v_exp_f32 v72, v72
    s_waitcnt lgkmcnt(3)
    v_mfma_f32_32x32x16_bf16 v[80:95], v[20:23], v[12:15], v[80:95]
    ds_read_b128 v[20:23], v1 offset:9216
    buffer_load_dwordx4 v[196:199], v3, s[32:35], s75 offen sc1
    s_add_u32 s75, s75, 8192
    v_exp_f32 v73, v73
    v_exp_f32 v74, v74
    v_exp_f32 v75, v75
    s_waitcnt lgkmcnt(3)
    v_mfma_f32_32x32x16_bf16 v[96:111], v[24:27], v[120:123], v[96:111]
    ds_read_b128 v[24:27], v1 offset:6144
    v_exp_f32 v76, v76
    v_exp_f32 v77, v77
    v_exp_f32 v78, v78
    v_mfma_f32_16x16x32_bf16 v[112:115], v[40:43], v[120:123], v[112:115]
    v_exp_f32 v79, v79
    v_cvt_pk_bf16_f32 v124, v72, v73
    v_cvt_pk_bf16_f32 v125, v74, v75
    v_cvt_pk_bf16_f32 v126, v76, v77
    v_cvt_pk_bf16_f32 v127, v78, v79
    s_cmp_eq_u32 s84, 0
    s_cbranch_scc1 KZ_14
    buffer_load_dword v224, v46, s[32:35], s76 offen offset:0 sc1
    buffer_load_dword v225, v46, s[32:35], s76 offen offset:256 sc1
KZ_14:
    s_setprio 2
    v_exp_f32 v80, v80
    v_exp_f32 v81, v81
    s_waitcnt lgkmcnt(3)
    v_mfma_f32_32x32x16_bf16 v[96:111], v[28:31], v[124:127], v[96:111]
    ds_read_b128 v[28:31], v1 offset:7168
    buffer_load_dwordx4 v[200:203], v3, s[32:35], s75 offen sc1
    s_add_u32 s75, s75, 8192
    v_exp_f32 v82, v82
    v_exp_f32 v83, v83
    v_exp_f32 v84, v84
    v_exp_f32 v85, v85
    s_waitcnt lgkmcnt(3)
    v_mfma_f32_32x32x16_bf16 v[64:79], v[16:19], v[8:11], v[48:63]
    ds_read_b128 v[16:19], v1 offset:12288
    v_exp_f32 v86, v86
    v_exp_f32 v87, v87
    v_cvt_pk_bf16_f32 v120, v80, v81
    v_cvt_pk_bf16_f32 v121, v82, v83
    v_mfma_f32_16x16x32_bf16 v[112:115], v[40:43], v[124:127], v[112:115]
    v_cvt_pk_bf16_f32 v122, v84, v85
    v_cvt_pk_bf16_f32 v123, v86, v87
    v_exp_f32 v88, v88
    s_waitcnt lgkmcnt(3)
    v_mfma_f32_32x32x16_bf16 v[64:79], v[20:23], v[12:15], v[64:79]
    ds_read_b128 v[20:23], v1 offset:13312
    buffer_load_dwordx4 v[204:207], v3, s[32:35], s75 offen sc1
    s_add_u32 s75, s75, 8192
    v_exp_f32 v89, v89
    v_exp_f32 v90, v90
    v_exp_f32 v91, v91
    s_waitcnt lgkmcnt(3)
    v_mfma_f32_32x32x16_bf16 v[96:111], v[24:27], v[120:123], v[96:111]
    ds_read_b128 v[24:27], v1 offset:10240
    v_exp_f32 v92, v92
    v_exp_f32 v93, v93
    v_exp_f32 v94, v94
    v_mfma_f32_16x16x32_bf16 v[112:115], v[40:43], v[120:123], v[112:115]
    v_exp_f32 v95, v95
    v_cvt_pk_bf16_f32 v124, v88, v89
    v_cvt_pk_bf16_f32 v125, v90, v91
    v_cvt_pk_bf16_f32 v126, v92, v93
    v_cvt_pk_bf16_f32 v127, v94, v95
    s_cmp_eq_u32 s84, 0
    s_cbranch_scc1 KZ_15
    buffer_load_dword v226, v46, s[32:35], s76 offen offset:512 sc1
    buffer_load_dword v227, v46, s[32:35], s76 offen offset:768 sc1
KZ_15:
    s_setprio 1
    v_exp_f32 v64, v64
    v_exp_f32 v65, v65
    s_waitcnt lgkmcnt(3)
    v_mfma_f32_32x32x16_bf16 v[96:111], v[28:31], v[124:127], v[96:111]
    ds_read_b128 v[28:31], v1 offset:11264
    buffer_load_dwordx4 v[208:211], v3, s[32:35], s75 offen sc1
    s_add_u32 s75, s75, 8192
    v_exp_f32 v66, v66
    v_exp_f32 v67, v67
    v_exp_f32 v68, v68
    v_exp_f32 v69, v69
    s_waitcnt lgkmcnt(3)
    v_mfma_f32_32x32x16_bf16 v[80:95], v[16:19], v[8:11], v[48:63]
    ds_read_b128 v[16:19], v2 offset:0
    v_exp_f32 v70, v70
    v_exp_f32 v71, v71
    v_cvt_pk_bf16_f32 v120, v64, v65
    v_cvt_pk_bf16_f32 v121, v66, v67
    v_mfma_f32_16x16x32_bf16 v[112:115], v[40:43], v[124:127], v[112:115]
    v_cvt_pk_bf16_f32 v122, v68, v69
    v_cvt_pk_bf16_f32 v123, v70, v71
    v_exp_f32 v72, v72
    s_waitcnt lgkmcnt(3)
    v_mfma_f32_32x32x16_bf16 v[80:95], v[20:23], v[12:15], v[80:95]
    ds_read_b128 v[20:23], v2 offset:1024
    buffer_load_dwordx4 v[212:215], v3, s[32:35], s75 offen sc1
    s_add_u32 s75, s75, 8192
    v_exp_f32 v73, v73
    v_exp_f32 v74, v74
    v_exp_f32 v75, v75
    s_waitcnt lgkmcnt(3)
    v_mfma_f32_32x32x16_bf16 v[96:111], v[24:27], v[120:123], v[96:111]
    ds_read_b128 v[24:27], v1 offset:14336
    v_exp_f32 v76, v76
    v_exp_f32 v77, v77
    v_exp_f32 v78, v78
    v_mfma_f32_16x16x32_bf16 v[112:115], v[40:43], v[120:123], v[112:115]
    v_exp_f32 v79, v79
    v_cvt_pk_bf16_f32 v124, v72, v73
    v_cvt_pk_bf16_f32 v125, v74, v75
    v_cvt_pk_bf16_f32 v126, v76, v77
    v_cvt_pk_bf16_f32 v127, v78, v79
    s_cmp_eq_u32 s84, 0
    s_cbranch_scc1 KZ_16
    buffer_load_dword v228, v46, s[32:35], s76 offen offset:1024 sc1
    buffer_load_dword v229, v46, s[32:35], s76 offen offset:1280 sc1
KZ_16:
    s_setprio 0
    v_exp_f32 v80, v80
    v_exp_f32 v81, v81
    s_waitcnt lgkmcnt(3)
    v_mfma_f32_32x32x16_bf16 v[96:111], v[28:31], v[124:127], v[96:111]
    ds_read_b128 v[28:31], v1 offset:15360
    buffer_load_dwordx4 v[216:219], v3, s[32:35], s75 offen sc1
    s_add_u32 s75, s75, 8192
    v_exp_f32 v82, v82
    v_exp_f32 v83, v83
    v_exp_f32 v84, v84
    v_exp_f32 v85, v85
    s_waitcnt lgkmcnt(3)
    v_mfma_f32_32x32x16_bf16 v[64:79], v[16:19], v[8:11], v[48:63]
    ds_read_b128 v[16:19], v2 offset:4096
    v_exp_f32 v86, v86
    v_exp_f32 v87, v87
    v_cvt_pk_bf16_f32 v120, v80, v81
    v_cvt_pk_bf16_f32 v121, v82, v83
    v_mfma_f32_16x16x32_bf16 v[112:115], v[40:43], v[124:127], v[112:115]
    v_cvt_pk_bf16_f32 v122, v84, v85
    v_cvt_pk_bf16_f32 v123, v86, v87
    v_exp_f32 v88, v88
    s_waitcnt lgkmcnt(3)
    v_mfma_f32_32x32x16_bf16 v[64:79], v[20:23], v[12:15], v[64:79]
    ds_read_b128 v[20:23], v2 offset:5120
    buffer_load_dwordx4 v[220:223], v3, s[32:35], s75 offen sc1
    s_add_u32 s75, s75, 8192
    v_exp_f32 v89, v89
    v_exp_f32 v90, v90
    v_exp_f32 v91, v91
    s_waitcnt lgkmcnt(3)
    v_mfma_f32_32x32x16_bf16 v[96:111], v[24:27], v[120:123], v[96:111]
    ds_read_b128 v[24:27], v2 offset:2048
    v_exp_f32 v92, v92
    v_exp_f32 v93, v93
    v_exp_f32 v94, v94
    v_mfma_f32_16x16x32_bf16 v[112:115], v[40:43], v[120:123], v[112:115]
    v_exp_f32 v95, v95
    v_cvt_pk_bf16_f32 v124, v88, v89
    v_cvt_pk_bf16_f32 v125, v90, v91
    v_cvt_pk_bf16_f32 v126, v92, v93
    v_cvt_pk_bf16_f32 v127, v94, v95
    s_cmp_eq_u32 s84, 0
    s_cbranch_scc1 KZ_17
    buffer_load_dword v230, v46, s[32:35], s76 offen offset:1536 sc1
    buffer_load_dword v231, v46, s[32:35], s76 offen offset:1792 sc1
KZ_17:
    v_mov_b32 v1, v2
    v_add_u32 v2, 16384, v2
    v_and_b32 v2, 65535, v2
    s_waitcnt vmcnt(10)
    s_barrier
    s_mov_b32 m0, s72
    s_add_u32 s81, s70, s71
    s_add_u32 s72, s72, 16384
    buffer_load_dwordx4 v3, s[32:35], s81 offen sc1 lds
    buffer_load_dwordx4 v3, s[32:35], s81 offen offset:1024 sc1 lds
    s_and_b32 s72, s72, 65535
    s_add_u32 s71, s71, 16384
    s_and_b32 s71, s71, 0x3ffff
    s_setprio 3
    v_exp_f32 v64, v64
    v_exp_f32 v65, v65
    s_waitcnt lgkmcnt(3)
    v_mfma_f32_32x32x16_bf16 v[96:111], v[28:31], v[124:127], v[96:111]
    ds_read_b128 v[28:31], v1 offset:3072
    v_exp_f32 v66, v66
    v_exp_f32 v67, v67
    v_exp_f32 v68, v68
    v_exp_f32 v69, v69
    s_waitcnt lgkmcnt(3)
    v_mfma_f32_32x32x16_bf16 v[80:95], v[16:19], v[8:11], v[48:63]
    ds_read_b128 v[16:19], v1 offset:8192
    v_exp_f32 v70, v70
    v_exp_f32 v71, v71
    v_cvt_pk_bf16_f32 v120, v64, v65
    v_cvt_pk_bf16_f32 v121, v66, v67
    v_mfma_f32_16x16x32_bf16 v[112:115], v[40:43], v[124:127], v[112:115]
    v_cvt_pk_bf16_f32 v122, v68, v69
    v_cvt_pk_bf16_f32 v123, v70, v71
    v_exp_f32 v72, v72
    s_waitcnt lgkmcnt(3)
    v_mfma_f32_32x32x16_bf16 v[80:95], v[20:23], v[12:15], v[80:95]
    ds_read_b128 v[20:23], v1 offset:9216
    v_exp_f32 v73, v73
    v_exp_f32 v74, v74
    v_exp_f32 v75, v75
    s_waitcnt lgkmcnt(3)
    v_mfma_f32_32x32x16_bf16 v[96:111], v[24:27], v[120:123], v[96:111]
    ds_read_b128 v[24:27], v1 offset:6144
    v_exp_f32 v76, v76
    v_exp_f32 v77, v77
    v_exp_f32 v78, v78
    v_mfma_f32_16x16x32_bf16 v[112:115], v[40:43], v[120:123], v[112:115]
    v_exp_f32 v79, v79
    v_cvt_pk_bf16_f32 v124, v72, v73
    v_cvt_pk_bf16_f32 v125, v74, v75
    v_cvt_pk_bf16_f32 v126, v76, v77
    v_cvt_pk_bf16_f32 v127, v78, v79
    s_setprio 2
    v_exp_f32 v80, v80
    v_exp_f32 v81, v81
    s_waitcnt lgkmcnt(3)
    v_mfma_f32_32x32x16_bf16 v[96:111], v[28:31], v[124:127], v[96:111]
    ds_read_b128 v[28:31], v1 offset:7168
    v_exp_f32 v82, v82
    v_exp_f32 v83, v83
    v_exp_f32 v84, v84
    v_exp_f32 v85, v85
    s_waitcnt lgkmcnt(3)
    v_mfma_f32_32x32x16_bf16 v[64:79], v[16:19], v[8:11], v[48:63]
    ds_read_b128 v[16:19], v1 offset:12288
    v_exp_f32 v86, v86
    v_exp_f32 v87, v87
    v_cvt_pk_bf16_f32 v120, v80, v81
    v_cvt_pk_bf16_f32 v121, v82, v83
    v_mfma_f32_16x16x32_bf16 v[112:115], v[40:43], v[124:127], v[112:115]
    v_cvt_pk_bf16_f32 v122, v84, v85
    v_cvt_pk_bf16_f32 v123, v86, v87
    v_exp_f32 v88, v88
    s_waitcnt lgkmcnt(3)
    v_mfma_f32_32x32x16_bf16 v[64:79], v[20:23], v[12:15], v[64:79]
    ds_read_b128 v[20:23], v1 offset:13312
    v_exp_f32 v89, v89
    v_exp_f32 v90, v90
    v_exp_f32 v91, v91
    s_waitcnt lgkmcnt(3)
    v_mfma_f32_32x32x16_bf16 v[96:111], v[24:27], v[120:123], v[96:111]
    ds_read_b128 v[24:27], v1 offset:10240
    v_exp_f32 v92, v92
    v_exp_f32 v93, v93
    v_exp_f32 v94, v94
    v_mfma_f32_16x16x32_bf16 v[112:115], v[40:43], v[120:123], v[112:115]
    v_exp_f32 v95, v95
    v_cvt_pk_bf16_f32 v124, v88, v89
    v_cvt_pk_bf16_f32 v125, v90, v91
    v_cvt_pk_bf16_f32 v126, v92, v93
    v_cvt_pk_bf16_f32 v127, v94, v95
    s_waitcnt vmcnt(2)
    s_lshr_b32 s47, s40, 1
    s_lshl_b32 s47, s47, 10
    s_and_b32 s38, s40, 1
    s_lshl_b32 s38, s38, 3
    s_add_u32 s47, s47, s38
    s_add_u32 s47, s47, 116736
    v_add_u32 v4, s47, v3
    v_pk_add_f32 v[192:193], v[192:193], v[196:197]
    v_pk_add_f32 v[194:195], v[194:195], v[198:199]
    v_pk_add_f32 v[192:193], v[192:193], v[200:201]
    v_pk_add_f32 v[194:195], v[194:195], v[202:203]
    v_pk_add_f32 v[192:193], v[192:193], v[204:205]
    v_pk_add_f32 v[194:195], v[194:195], v[206:207]
    v_pk_add_f32 v[192:193], v[192:193], v[208:209]
    v_pk_add_f32 v[194:195], v[194:195], v[210:211]
    v_pk_add_f32 v[192:193], v[192:193], v[212:213]
    v_pk_add_f32 v[194:195], v[194:195], v[214:215]
    v_pk_add_f32 v[192:193], v[192:193], v[216:217]
    v_pk_add_f32 v[194:195], v[194:195], v[218:219]
    v_pk_add_f32 v[192:193], v[192:193], v[220:221]
    v_pk_add_f32 v[194:195], v[194:195], v[222:223]
    v_cvt_pk_bf16_f32 v192, v192, v193
    v_cvt_pk_bf16_f32 v193, v194, v195
    ds_write_b64 v4, v[192:193]
    s_cmp_eq_u32 s84, 0
    s_cbranch_scc1 KZS_18
    v_add_f32 v224, v224, v225
    v_add_f32 v224, v224, v226
    v_add_f32 v224, v224, v227
    v_add_f32 v224, v224, v228
    v_add_f32 v224, v224, v229
    v_add_f32 v224, v224, v230
    v_add_f32 v224, v224, v231
    v_lshlrev_b32 v5, 1, v0
    v_add_u32 v5, 120832, v5
    v_cvt_pk_bf16_f32 v224, v224, v224
    ds_write_b16 v5, v224
KZS_18:
    s_setprio 1
    v_exp_f32 v64, v64
    v_exp_f32 v65, v65
    s_waitcnt lgkmcnt(3)
    v_mfma_f32_32x32x16_bf16 v[96:111], v[28:31], v[124:127], v[96:111]
    ds_read_b128 v[28:31], v1 offset:11264
    v_exp_f32 v66, v66
    v_exp_f32 v67, v67
    v_exp_f32 v68, v68
    v_exp_f32 v69, v69
    s_waitcnt lgkmcnt(3)
    v_mfma_f32_32x32x16_bf16 v[80:95], v[16:19], v[8:11], v[48:63]
    ds_read_b128 v[16:19], v2 offset:0
    v_exp_f32 v70, v70
    v_exp_f32 v71, v71
    v_cvt_pk_bf16_f32 v120, v64, v65
    v_cvt_pk_bf16_f32 v121, v66, v67
    v_mfma_f32_16x16x32_bf16 v[112:115], v[40:43], v[124:127], v[112:115]
    v_cvt_pk_bf16_f32 v122, v68, v69
    v_cvt_pk_bf16_f32 v123, v70, v71
    v_exp_f32 v72, v72
    s_waitcnt lgkmcnt(3)
    v_mfma_f32_32x32x16_bf16 v[80:95], v[20:23], v[12:15], v[80:95]
    ds_read_b128 v[20:23], v2 offset:1024
    v_exp_f32 v73, v73
    v_exp_f32 v74, v74
    v_exp_f32 v75, v75
    s_waitcnt lgkmcnt(3)
    v_mfma_f32_32x32x16_bf16 v[96:111], v[24:27], v[120:123], v[96:111]
    ds_read_b128 v[24:27], v1 offset:14336
    v_exp_f32 v76, v76
    v_exp_f32 v77, v77
    v_exp_f32 v78, v78
    v_mfma_f32_16x16x32_bf16 v[112:115], v[40:43], v[120:123], v[112:115]
    v_exp_f32 v79, v79
    v_cvt_pk_bf16_f32 v124, v72, v73
    v_cvt_pk_bf16_f32 v125, v74, v75
    v_cvt_pk_bf16_f32 v126, v76, v77
    v_cvt_pk_bf16_f32 v127, v78, v79
    s_setprio 0
    v_exp_f32 v80, v80
    v_exp_f32 v81, v81
    s_waitcnt lgkmcnt(3)
    v_mfma_f32_32x32x16_bf16 v[96:111], v[28:31], v[124:127], v[96:111]
    ds_read_b128 v[28:31], v1 offset:15360
    v_exp_f32 v82, v82
    v_exp_f32 v83, v83
    v_exp_f32 v84, v84
    v_exp_f32 v85, v85
    s_waitcnt lgkmcnt(3)
    v_mfma_f32_32x32x16_bf16 v[64:79], v[16:19], v[8:11], v[48:63]
    ds_read_b128 v[16:19], v2 offset:4096
    v_exp_f32 v86, v86
    v_exp_f32 v87, v87
    v_cvt_pk_bf16_f32 v120, v80, v81
    v_cvt_pk_bf16_f32 v121, v82, v83
    v_mfma_f32_16x16x32_bf16 v[112:115], v[40:43], v[124:127], v[112:115]
    v_cvt_pk_bf16_f32 v122, v84, v85
    v_cvt_pk_bf16_f32 v123, v86, v87
    v_exp_f32 v88, v88
    s_waitcnt lgkmcnt(3)
    v_mfma_f32_32x32x16_bf16 v[64:79], v[20:23], v[12:15], v[64:79]
    ds_read_b128 v[20:23], v2 offset:5120
    v_exp_f32 v89, v89
    v_exp_f32 v90, v90
    v_exp_f32 v91, v91
    s_waitcnt lgkmcnt(3)
    v_mfma_f32_32x32x16_bf16 v[96:111], v[24:27], v[120:123], v[96:111]
    ds_read_b128 v[24:27], v2 offset:2048
    v_exp_f32 v92, v92
    v_exp_f32 v93, v93
    v_exp_f32 v94, v94
    v_mfma_f32_16x16x32_bf16 v[112:115], v[40:43], v[120:123], v[112:115]
    v_exp_f32 v95, v95
    v_cvt_pk_bf16_f32 v124, v88, v89
    v_cvt_pk_bf16_f32 v125, v90, v91
    v_cvt_pk_bf16_f32 v126, v92, v93
    v_cvt_pk_bf16_f32 v127, v94, v95
    v_mov_b32 v1, v2
    v_add_u32 v2, 16384, v2
    v_and_b32 v2, 65535, v2
    s_barrier
    s_mov_b32 s60, 6
    s_mov_b32 s61, 7
    s_lshr_b32 s47, s40, 2
    s_xor_b32 s47, s47, s40
    s_and_b32 s47, s47, 1
    s_cmp_lg_u32 s47, 1
    s_cbranch_scc1 K2_LOOP
    v_add_u32 v4, 116736, v3
    v_lshrrev_b32 v5, 5, v0
    v_lshlrev_b32 v5, 3, v5
    v_add_u32 v5, 120832, v5
    ds_read_b128 v[192:195], v4 offset:0
    ds_read_b64 v[208:209], v5 offset:0
    ds_read_b64 v[210:211], v5 offset:16
    ds_read_b128 v[196:199], v4 offset:1024
    ds_read_b64 v[212:213], v5 offset:32
    ds_read_b64 v[214:215], v5 offset:48
    ds_read_b128 v[200:203], v4 offset:2048
    ds_read_b64 v[216:217], v5 offset:64
    ds_read_b64 v[218:219], v5 offset:80
    ds_read_b128 v[204:207], v4 offset:3072
    ds_read_b64 v[220:221], v5 offset:96
    ds_read_b64 v[222:223], v5 offset:112
    s_mov_b32 m0, s72
    s_add_u32 s81, s70, s71
    s_add_u32 s72, s72, 16384
    buffer_load_dwordx4 v3, s[32:35], s81 offen sc1 lds
    buffer_load_dwordx4 v3, s[32:35], s81 offen offset:1024 sc1 lds
    s_and_b32 s72, s72, 65535
    s_add_u32 s71, s71, 16384
    s_and_b32 s71, s71, 0x3ffff
    s_setprio 3
    v_exp_f32 v64, v64
    v_exp_f32 v65, v65
    s_waitcnt lgkmcnt(3)
    v_mfma_f32_32x32x16_bf16 v[96:111], v[28:31], v[124:127], v[96:111]
    ds_read_b128 v[28:31], v1 offset:3072
    v_exp_f32 v66, v66
    v_exp_f32 v67, v67
    v_exp_f32 v68, v68
    v_exp_f32 v69, v69
    s_waitcnt lgkmcnt(3)
    v_mfma_f32_32x32x16_bf16 v[80:95], v[16:19], v[8:11], v[48:63]
    ds_read_b128 v[16:19], v1 offset:8192
    v_exp_f32 v70, v70
    v_exp_f32 v71, v71
    v_cvt_pk_bf16_f32 v120, v64, v65
    v_cvt_pk_bf16_f32 v121, v66, v67
    v_mfma_f32_16x16x32_bf16 v[112:115], v[40:43], v[124:127], v[112:115]
    v_cvt_pk_bf16_f32 v122, v68, v69
    v_cvt_pk_bf16_f32 v123, v70, v71
    v_exp_f32 v72, v72
    s_waitcnt lgkmcnt(3)
    v_mfma_f32_32x32x16_bf16 v[80:95], v[20:23], v[12:15], v[80:95]
    ds_read_b128 v[20:23], v1 offset:9216
    v_exp_f32 v73, v73
    v_exp_f32 v74, v74
    v_exp_f32 v75, v75
    s_waitcnt lgkmcnt(3)
    v_mfma_f32_32x32x16_bf16 v[96:111], v[24:27], v[120:123], v[96:111]
    ds_read_b128 v[24:27], v1 offset:6144
    v_exp_f32 v76, v76
    v_exp_f32 v77, v77
    v_exp_f32 v78, v78
    v_mfma_f32_16x16x32_bf16 v[112:115], v[40:43], v[120:123], v[112:115]
    v_exp_f32 v79, v79
    v_cvt_pk_bf16_f32 v124, v72, v73
    v_cvt_pk_bf16_f32 v125, v74, v75
    v_cvt_pk_bf16_f32 v126, v76, v77
    v_cvt_pk_bf16_f32 v127, v78, v79
    v_bfe_u32 v4, v0, 2, 1
    v_bfe_u32 v5, v0, 4, 1
    v_cmp_eq_u32 vcc, v4, v5
    v_mov_b32 v4, 0
    s_nop 0
    v_cndmask_b32 v208, v4, v208, vcc
    v_cndmask_b32 v209, v4, v209, vcc
    v_cndmask_b32 v210, v4, v210, vcc
    v_cndmask_b32 v211, v4, v211, vcc
    v_cndmask_b32 v212, v4, v212, vcc
    v_cndmask_b32 v213, v4, v213, vcc
    v_cndmask_b32 v214, v4, v214, vcc
    v_cndmask_b32 v215, v4, v215, vcc
    v_cndmask_b32 v216, v4, v216, vcc
    v_cndmask_b32 v217, v4, v217, vcc
    v_cndmask_b32 v218, v4, v218, vcc
    v_cndmask_b32 v219, v4, v219, vcc
    v_cndmask_b32 v220, v4, v220, vcc
    v_cndmask_b32 v221, v4, v221, vcc
    v_cndmask_b32 v222, v4, v222, vcc
    v_cndmask_b32 v223, v4, v223, vcc
    v_mfma_f32_32x32x16_bf16 v[224:239], v[192:195], v[128:131], 0
    v_mfma_f32_16x16x32_bf16 v[240:243], v[208:211], v[128:131], 0
    v_mfma_f32_32x32x16_bf16 v[224:239], v[196:199], v[132:135], v[224:239]
    v_mfma_f32_16x16x32_bf16 v[240:243], v[212:215], v[132:135], v[240:243]
    v_mfma_f32_32x32x16_bf16 v[224:239], v[200:203], v[136:139], v[224:239]
    v_mfma_f32_16x16x32_bf16 v[240:243], v[216:219], v[136:139], v[240:243]
    v_mfma_f32_32x32x16_bf16 v[224:239], v[204:207], v[140:143], v[224:239]
    v_mfma_f32_16x16x32_bf16 v[240:243], v[220:223], v[140:143], v[240:243]
    s_setprio 2
    v_exp_f32 v80, v80
    v_exp_f32 v81, v81
    s_waitcnt lgkmcnt(3)
    v_mfma_f32_32x32x16_bf16 v[96:111], v[28:31], v[124:127], v[96:111]
    ds_read_b128 v[28:31], v1 offset:7168
    v_exp_f32 v82, v82
    v_exp_f32 v83, v83
    v_exp_f32 v84, v84
    v_exp_f32 v85, v85
    s_waitcnt lgkmcnt(3)
    v_mfma_f32_32x32x16_bf16 v[64:79], v[16:19], v[8:11], v[48:63]
    ds_read_b128 v[16:19], v1 offset:12288
    v_exp_f32 v86, v86
    v_exp_f32 v87, v87
    v_cvt_pk_bf16_f32 v120, v80, v81
    v_cvt_pk_bf16_f32 v121, v82, v83
    v_mfma_f32_16x16x32_bf16 v[112:115], v[40:43], v[124:127], v[112:115]
    v_cvt_pk_bf16_f32 v122, v84, v85
    v_cvt_pk_bf16_f32 v123, v86, v87
    v_exp_f32 v88, v88
    s_waitcnt lgkmcnt(3)
    v_mfma_f32_32x32x16_bf16 v[64:79], v[20:23], v[12:15], v[64:79]
    ds_read_b128 v[20:23], v1 offset:13312
    v_exp_f32 v89, v89
    v_exp_f32 v90, v90
    v_exp_f32 v91, v91
    s_waitcnt lgkmcnt(3)
    v_mfma_f32_32x32x16_bf16 v[96:111], v[24:27], v[120:123], v[96:111]
    ds_read_b128 v[24:27], v1 offset:10240
    v_exp_f32 v92, v92
    v_exp_f32 v93, v93
    v_exp_f32 v94, v94
    v_mfma_f32_16x16x32_bf16 v[112:115], v[40:43], v[120:123], v[112:115]
    v_exp_f32 v95, v95
    v_cvt_pk_bf16_f32 v124, v88, v89
    v_cvt_pk_bf16_f32 v125, v90, v91
    v_cvt_pk_bf16_f32 v126, v92, v93
    v_cvt_pk_bf16_f32 v127, v94, v95
    v_add_f32 v4, 0x358637bd, v240
    v_rcp_f32 v4, v4
    s_nop 0
    v_pk_mul_f32 v[224:225], v[224:225], v[4:5] op_sel_hi:[1,0]
    v_pk_mul_f32 v[226:227], v[226:227], v[4:5] op_sel_hi:[1,0]
    v_pk_mul_f32 v[228:229], v[228:229], v[4:5] op_sel_hi:[1,0]
    v_pk_mul_f32 v[230:231], v[230:231], v[4:5] op_sel_hi:[1,0]
    v_pk_mul_f32 v[232:233], v[232:233], v[4:5] op_sel_hi:[1,0]
    v_pk_mul_f32 v[234:235], v[234:235], v[4:5] op_sel_hi:[1,0]
    v_pk_mul_f32 v[236:237], v[236:237], v[4:5] op_sel_hi:[1,0]
    v_pk_mul_f32 v[238:239], v[238:239], v[4:5] op_sel_hi:[1,0]
    v_cvt_pk_bf16_f32 v244, v224, v225
    v_cvt_pk_bf16_f32 v245, v226, v227
    v_cvt_pk_bf16_f32 v246, v228, v229
    v_cvt_pk_bf16_f32 v247, v230, v231
    v_cvt_pk_bf16_f32 v248, v232, v233
    v_cvt_pk_bf16_f32 v249, v234, v235
    v_cvt_pk_bf16_f32 v250, v236, v237
    v_cvt_pk_bf16_f32 v251, v238, v239
    buffer_store_dwordx4 v[244:247], v3, s[32:35], s74 offen sc1
    buffer_store_dwordx4 v[248:251], v3, s[32:35], s74 offen offset:1024 sc1
    s_add_u32 s74, s74, 65536
    v_mfma_f32_32x32x16_bf16 v[224:239], v[192:195], v[144:147], 0
    v_mfma_f32_16x16x32_bf16 v[240:243], v[208:211], v[144:147], 0
    v_mfma_f32_32x32x16_bf16 v[224:239], v[196:199], v[148:151], v[224:239]
    v_mfma_f32_16x16x32_bf16 v[240:243], v[212:215], v[148:151], v[240:243]
    v_mfma_f32_32x32x16_bf16 v[224:239], v[200:203], v[152:155], v[224:239]
    v_mfma_f32_16x16x32_bf16 v[240:243], v[216:219], v[152:155], v[240:243]
    v_mfma_f32_32x32x16_bf16 v[224:239], v[204:207], v[156:159], v[224:239]
    v_mfma_f32_16x16x32_bf16 v[240:243], v[220:223], v[156:159], v[240:243]
    s_setprio 1
    v_exp_f32 v64, v64
    v_exp_f32 v65, v65
    s_waitcnt lgkmcnt(3)
    v_mfma_f32_32x32x16_bf16 v[96:111], v[28:31], v[124:127], v[96:111]
    ds_read_b128 v[28:31], v1 offset:11264
    v_exp_f32 v66, v66
    v_exp_f32 v67, v67
    v_exp_f32 v68, v68
    v_exp_f32 v69, v69
    s_waitcnt lgkmcnt(3)
    v_mfma_f32_32x32x16_bf16 v[80:95], v[16:19], v[8:11], v[48:63]
    ds_read_b128 v[16:19], v2 offset:0
    v_exp_f32 v70, v70
    v_exp_f32 v71, v71
    v_cvt_pk_bf16_f32 v120, v64, v65
    v_cvt_pk_bf16_f32 v121, v66, v67
    v_mfma_f32_16x16x32_bf16 v[112:115], v[40:43], v[124:127], v[112:115]
    v_cvt_pk_bf16_f32 v122, v68, v69
    v_cvt_pk_bf16_f32 v123, v70, v71
    v_exp_f32 v72, v72
    s_waitcnt lgkmcnt(3)
    v_mfma_f32_32x32x16_bf16 v[80:95], v[20:23], v[12:15], v[80:95]
    ds_read_b128 v[20:23], v2 offset:1024
    v_exp_f32 v73, v73
    v_exp_f32 v74, v74
    v_exp_f32 v75, v75
    s_waitcnt lgkmcnt(3)
    v_mfma_f32_32x32x16_bf16 v[96:111], v[24:27], v[120:123], v[96:111]
    ds_read_b128 v[24:27], v1 offset:14336
    v_exp_f32 v76, v76
    v_exp_f32 v77, v77
    v_exp_f32 v78, v78
    v_mfma_f32_16x16x32_bf16 v[112:115], v[40:43], v[120:123], v[112:115]
    v_exp_f32 v79, v79
    v_cvt_pk_bf16_f32 v124, v72, v73
    v_cvt_pk_bf16_f32 v125, v74, v75
    v_cvt_pk_bf16_f32 v126, v76, v77
    v_cvt_pk_bf16_f32 v127, v78, v79
    v_add_f32 v4, 0x358637bd, v240
    v_rcp_f32 v4, v4
    s_nop 0
    v_pk_mul_f32 v[224:225], v[224:225], v[4:5] op_sel_hi:[1,0]
    v_pk_mul_f32 v[226:227], v[226:227], v[4:5] op_sel_hi:[1,0]
    v_pk_mul_f32 v[228:229], v[228:229], v[4:5] op_sel_hi:[1,0]
    v_pk_mul_f32 v[230:231], v[230:231], v[4:5] op_sel_hi:[1,0]
    v_pk_mul_f32 v[232:233], v[232:233], v[4:5] op_sel_hi:[1,0]
    v_pk_mul_f32 v[234:235], v[234:235], v[4:5] op_sel_hi:[1,0]
    v_pk_mul_f32 v[236:237], v[236:237], v[4:5] op_sel_hi:[1,0]
    v_pk_mul_f32 v[238:239], v[238:239], v[4:5] op_sel_hi:[1,0]
    v_cvt_pk_bf16_f32 v244, v224, v225
    v_cvt_pk_bf16_f32 v245, v226, v227
    v_cvt_pk_bf16_f32 v246, v228, v229
    v_cvt_pk_bf16_f32 v247, v230, v231
    v_cvt_pk_bf16_f32 v248, v232, v233
    v_cvt_pk_bf16_f32 v249, v234, v235
    v_cvt_pk_bf16_f32 v250, v236, v237
    v_cvt_pk_bf16_f32 v251, v238, v239
    buffer_store_dwordx4 v[244:247], v3, s[32:35], s74 offen sc1
    buffer_store_dwordx4 v[248:251], v3, s[32:35], s74 offen offset:1024 sc1
    s_add_u32 s74, s74, 65536
    s_setprio 0
    v_exp_f32 v80, v80
    v_exp_f32 v81, v81
    s_waitcnt lgkmcnt(3)
    v_mfma_f32_32x32x16_bf16 v[96:111], v[28:31], v[124:127], v[96:111]
    ds_read_b128 v[28:31], v1 offset:15360
    v_exp_f32 v82, v82
    v_exp_f32 v83, v83
    v_exp_f32 v84, v84
    v_exp_f32 v85, v85
    s_waitcnt lgkmcnt(3)
    v_mfma_f32_32x32x16_bf16 v[64:79], v[16:19], v[8:11], v[48:63]
    ds_read_b128 v[16:19], v2 offset:4096
    v_exp_f32 v86, v86
    v_exp_f32 v87, v87
    v_cvt_pk_bf16_f32 v120, v80, v81
    v_cvt_pk_bf16_f32 v121, v82, v83
    v_mfma_f32_16x16x32_bf16 v[112:115], v[40:43], v[124:127], v[112:115]
    v_cvt_pk_bf16_f32 v122, v84, v85
    v_cvt_pk_bf16_f32 v123, v86, v87
    v_exp_f32 v88, v88
    s_waitcnt lgkmcnt(3)
    v_mfma_f32_32x32x16_bf16 v[64:79], v[20:23], v[12:15], v[64:79]
    ds_read_b128 v[20:23], v2 offset:5120
    v_exp_f32 v89, v89
    v_exp_f32 v90, v90
    v_exp_f32 v91, v91
    s_waitcnt lgkmcnt(3)
    v_mfma_f32_32x32x16_bf16 v[96:111], v[24:27], v[120:123], v[96:111]
    ds_read_b128 v[24:27], v2 offset:2048
    v_exp_f32 v92, v92
    v_exp_f32 v93, v93
    v_exp_f32 v94, v94
    v_mfma_f32_16x16x32_bf16 v[112:115], v[40:43], v[120:123], v[112:115]
    v_exp_f32 v95, v95
    v_cvt_pk_bf16_f32 v124, v88, v89
    v_cvt_pk_bf16_f32 v125, v90, v91
    v_cvt_pk_bf16_f32 v126, v92, v93
    v_cvt_pk_bf16_f32 v127, v94, v95
    v_mov_b32 v1, v2
    v_add_u32 v2, 16384, v2
    v_and_b32 v2, 65535, v2
    s_waitcnt vmcnt(6)
    s_barrier
KD_7:
    s_mov_b32 s60, 7
    v_and_b32 v45, 31, v0
    v_lshlrev_b32 v45, 2, v45
    v_lshlrev_b32 v35, 2, v0
    v_lshrrev_b32 v4, 3, v0
    v_lshlrev_b32 v5, 11, v4
    v_and_b32 v7, 7, v0
    v_bfe_u32 v6, v0, 4, 2
    v_lshlrev_b32 v6, 1, v6
    v_xor_b32 v7, v7, v6
    v_lshl_add_u32 v5, v7, 4, v5
    s_lshl_b32 s47, s18, 9
    s_lshl_b32 s38, s19, 4
    s_add_u32 s47, s47, s38
    s_lshl_b32 s47, s47, 11
    s_lshl_b32 s38, s17, 7
    s_add_u32 s47, s47, s38
    v_add_u32 v36, s47, v5
    v_add_u32 v37, 15360, v36
    v_lshrrev_b32 v7, 5, v0
    v_bfe_u32 v6, v0, 2, 2
    v_lshl_add_u32 v7, v7, 2, v6
    v_lshlrev_b32 v7, 7, v7
    v_bfe_u32 v6, v0, 4, 1
    v_bfe_u32 v5, v0, 1, 1
    v_lshl_add_u32 v6, v6, 1, v5
    v_bfe_u32 v5, v0, 3, 1
    v_lshlrev_b32 v5, 2, v5
    v_xor_b32 v6, v6, v5
    v_lshl_add_u32 v7, v6, 4, v7
    v_and_b32 v5, 1, v0
    v_lshl_add_u32 v7, v5, 3, v7
    s_lshl_b32 s38, s18, 13
    v_add_u32 v38, s38, v7
    v_xor_b32 v39, 64, v38
    s_add_u32 s80, s30, 65536
    v_lshrrev_b32 v4, 4, v0
    v_and_b32 v5, 15, v0
    v_lshlrev_b32 v39, 4, v5
    v_lshl_add_u32 v39, v4, 9, v39
    v_lshrrev_b32 v6, 1, v4
    v_lshlrev_b32 v6, 4, v6
    v_and_b32 v7, 1, v4
    v_lshl_add_u32 v6, v7, 2, v6
    v_lshrrev_b32 v5, 2, v5
    v_add_u32 v6, v6, v5
    v_lshlrev_b32 v38, 7, v6
    v_bfe_u32 v6, v6, 1, 2
    v_lshl_add_u32 v38, v6, 5, v38
    v_and_b32 v5, 3, v0
    v_lshl_add_u32 v38, v5, 3, v38
    v_add_u32 v38, s38, v38
    v_and_b32 v45, 15, v0
    v_lshlrev_b32 v45, 2, v45
K2_LOOPB:
    s_setprio 3
    v_exp_f32 v64, v64
    v_exp_f32 v65, v65
    s_waitcnt lgkmcnt(3)
    v_mfma_f32_32x32x16_bf16 v[96:111], v[28:31], v[124:127], v[96:111]
    ds_read_b128 v[28:31], v1 offset:3072
    s_mov_b32 m0, s80
    s_nop 0
    buffer_load_dwordx4 v36, s[20:23], s29 offen lds
    v_exp_f32 v66, v66
    v_exp_f32 v67, v67
    v_exp_f32 v68, v68
    v_exp_f32 v69, v69
    s_waitcnt lgkmcnt(3)
    v_mfma_f32_32x32x16_bf16 v[80:95], v[16:19], v[8:11], v[48:63]
    ds_read_b128 v[16:19], v1 offset:8192
    v_exp_f32 v70, v70
    v_exp_f32 v71, v71
    v_cvt_pk_bf16_f32 v120, v64, v65
    v_cvt_pk_bf16_f32 v121, v66, v67
    v_mfma_f32_16x16x32_bf16 v[112:115], v[40:43], v[124:127], v[112:115]
    v_cvt_pk_bf16_f32 v122, v68, v69
    v_cvt_pk_bf16_f32 v123, v70, v71
    v_exp_f32 v72, v72
    s_waitcnt lgkmcnt(3)
    v_mfma_f32_32x32x16_bf16 v[80:95], v[20:23], v[12:15], v[80:95]
    ds_read_b128 v[20:23], v1 offset:9216
    buffer_load_dwordx4 v37, s[20:23], s29 offen offset:1024 lds
    s_add_u32 s29, s29, 131072
    s_add_u32 s80, s80, 16384
    v_exp_f32 v73, v73
    v_exp_f32 v74, v74
    v_exp_f32 v75, v75
    s_waitcnt lgkmcnt(3)
    v_mfma_f32_32x32x16_bf16 v[96:111], v[24:27], v[120:123], v[96:111]
    ds_read_b128 v[24:27], v1 offset:6144
    v_exp_f32 v76, v76
    v_exp_f32 v77, v77
    v_exp_f32 v78, v78
    v_mfma_f32_16x16x32_bf16 v[112:115], v[40:43], v[120:123], v[112:115]
    v_exp_f32 v79, v79
    v_cvt_pk_bf16_f32 v124, v72, v73
    v_cvt_pk_bf16_f32 v125, v74, v75
    v_cvt_pk_bf16_f32 v126, v76, v77
    v_cvt_pk_bf16_f32 v127, v78, v79
    s_setprio 2
    v_exp_f32 v80, v80
    v_exp_f32 v81, v81
    s_waitcnt lgkmcnt(3)
    v_mfma_f32_32x32x16_bf16 v[96:111], v[28:31], v[124:127], v[96:111]
    ds_read_b128 v[28:31], v1 offset:7168
    s_mov_b32 m0, s80
    s_nop 0
    buffer_load_dwordx4 v36, s[20:23], s29 offen lds
    v_exp_f32 v82, v82
    v_exp_f32 v83, v83
    v_exp_f32 v84, v84
    v_exp_f32 v85, v85
    s_waitcnt lgkmcnt(3)
    v_mfma_f32_32x32x16_bf16 v[64:79], v[16:19], v[8:11], v[48:63]
    ds_read_b128 v[16:19], v1 offset:12288
    v_exp_f32 v86, v86
    v_exp_f32 v87, v87
    v_cvt_pk_bf16_f32 v120, v80, v81
    v_cvt_pk_bf16_f32 v121, v82, v83
    v_mfma_f32_16x16x32_bf16 v[112:115], v[40:43], v[124:127], v[112:115]
    v_cvt_pk_bf16_f32 v122, v84, v85
    v_cvt_pk_bf16_f32 v123, v86, v87
    v_exp_f32 v88, v88
    s_waitcnt lgkmcnt(3)
    v_mfma_f32_32x32x16_bf16 v[64:79], v[20:23], v[12:15], v[64:79]
    ds_read_b128 v[20:23], v1 offset:13312
    buffer_load_dwordx4 v37, s[20:23], s29 offen offset:1024 lds
    s_add_u32 s29, s29, 131072
    s_add_u32 s80, s80, 16384
    v_exp_f32 v89, v89
    v_exp_f32 v90, v90
    v_exp_f32 v91, v91
    s_waitcnt lgkmcnt(3)
    v_mfma_f32_32x32x16_bf16 v[96:111], v[24:27], v[120:123], v[96:111]
    ds_read_b128 v[24:27], v1 offset:10240
    v_exp_f32 v92, v92
    v_exp_f32 v93, v93
    v_exp_f32 v94, v94
    v_mfma_f32_16x16x32_bf16 v[112:115], v[40:43], v[120:123], v[112:115]
    v_exp_f32 v95, v95
    v_cvt_pk_bf16_f32 v124, v88, v89
    v_cvt_pk_bf16_f32 v125, v90, v91
    v_cvt_pk_bf16_f32 v126, v92, v93
    v_cvt_pk_bf16_f32 v127, v94, v95
    s_setprio 1
    v_exp_f32 v64, v64
    v_exp_f32 v65, v65
    s_waitcnt lgkmcnt(3)
    v_mfma_f32_32x32x16_bf16 v[96:111], v[28:31], v[124:127], v[96:111]
    ds_read_b128 v[28:31], v1 offset:11264
    s_mov_b32 m0, s72
    s_add_u32 s81, s70, s71
    s_add_u32 s72, s72, 16384
    buffer_load_dwordx4 v3, s[32:35], s81 offen sc1 lds
    v_exp_f32 v66, v66
    v_exp_f32 v67, v67
    v_exp_f32 v68, v68
    v_exp_f32 v69, v69
    s_waitcnt lgkmcnt(3)
    v_mfma_f32_32x32x16_bf16 v[80:95], v[16:19], v[8:11], v[48:63]
    ds_read_b128 v[16:19], v2 offset:0
    v_exp_f32 v70, v70
    v_exp_f32 v71, v71
    v_cvt_pk_bf16_f32 v120, v64, v65
    v_cvt_pk_bf16_f32 v121, v66, v67
    v_mfma_f32_16x16x32_bf16 v[112:115], v[40:43], v[124:127], v[112:115]
    v_cvt_pk_bf16_f32 v122, v68, v69
    v_cvt_pk_bf16_f32 v123, v70, v71
    v_exp_f32 v72, v72
    s_waitcnt lgkmcnt(3)
    v_mfma_f32_32x32x16_bf16 v[80:95], v[20:23], v[12:15], v[80:95]
    ds_read_b128 v[20:23], v2 offset:1024
    buffer_load_dwordx4 v3, s[32:35], s81 offen offset:1024 sc1 lds
    s_and_b32 s72, s72, 65535
    s_add_u32 s71, s71, 16384
    s_and_b32 s71, s71, 0x3ffff
    v_exp_f32 v73, v73
    v_exp_f32 v74, v74
    v_exp_f32 v75, v75
    s_waitcnt lgkmcnt(3)
    v_mfma_f32_32x32x16_bf16 v[96:111], v[24:27], v[120:123], v[96:111]
    ds_read_b128 v[24:27], v1 offset:14336
    v_exp_f32 v76, v76
    v_exp_f32 v77, v77
    v_exp_f32 v78, v78
    v_mfma_f32_16x16x32_bf16 v[112:115], v[40:43], v[120:123], v[112:115]
    v_exp_f32 v79, v79
    v_cvt_pk_bf16_f32 v124, v72, v73
    v_cvt_pk_bf16_f32 v125, v74, v75
    v_cvt_pk_bf16_f32 v126, v76, v77
    v_cvt_pk_bf16_f32 v127, v78, v79
    s_setprio 0
    v_exp_f32 v80, v80
    v_exp_f32 v81, v81
    s_waitcnt lgkmcnt(3)
    v_mfma_f32_32x32x16_bf16 v[96:111], v[28:31], v[124:127], v[96:111]
    ds_read_b128 v[28:31], v1 offset:15360
    v_exp_f32 v82, v82
    v_exp_f32 v83, v83
    v_exp_f32 v84, v84
    v_exp_f32 v85, v85
    s_waitcnt lgkmcnt(3)
    v_mfma_f32_32x32x16_bf16 v[64:79], v[16:19], v[8:11], v[48:63]
    ds_read_b128 v[16:19], v2 offset:4096
    v_exp_f32 v86, v86
    v_exp_f32 v87, v87
    v_cvt_pk_bf16_f32 v120, v80, v81
    v_cvt_pk_bf16_f32 v121, v82, v83
    v_mfma_f32_16x16x32_bf16 v[112:115], v[40:43], v[124:127], v[112:115]
    v_cvt_pk_bf16_f32 v122, v84, v85
    v_cvt_pk_bf16_f32 v123, v86, v87
    v_exp_f32 v88, v88
    s_waitcnt lgkmcnt(3)
    v_mfma_f32_32x32x16_bf16 v[64:79], v[20:23], v[12:15], v[64:79]
    ds_read_b128 v[20:23], v2 offset:5120
    v_exp_f32 v89, v89
    v_exp_f32 v90, v90
    v_exp_f32 v91, v91
    s_waitcnt lgkmcnt(3)
    v_mfma_f32_32x32x16_bf16 v[96:111], v[24:27], v[120:123], v[96:111]
    ds_read_b128 v[24:27], v2 offset:2048
    v_exp_f32 v92, v92
    v_exp_f32 v93, v93
    v_exp_f32 v94, v94
    v_mfma_f32_16x16x32_bf16 v[112:115], v[40:43], v[120:123], v[112:115]
    v_exp_f32 v95, v95
    v_cvt_pk_bf16_f32 v124, v88, v89
    v_cvt_pk_bf16_f32 v125, v90, v91
    v_cvt_pk_bf16_f32 v126, v92, v93
    v_cvt_pk_bf16_f32 v127, v94, v95
    v_mov_b32 v1, v2
    v_add_u32 v2, 16384, v2
    v_and_b32 v2, 65535, v2
    s_add_u32 s60, s60, 1
    s_cmp_eq_u32 s60, 10
    s_waitcnt vmcnt(6)
    s_barrier
    s_cbranch_scc1 KB_10
    s_cmp_eq_u32 s60, 9
    s_cbranch_scc1 KB_9
    s_and_b32 s47, s40, 5
    s_cmp_lg_u32 s47, 1
    s_cbranch_scc1 K2_LOOPB
    s_mov_b64 exec, 1
    v_mov_b32 v4, 1
    v_mov_b32 v5, 0
    buffer_store_dword v4, v5, s[32:35], s88 offen sc1
    s_mov_b64 exec, -1
    s_branch K2_LOOPB
KB_9:
    buffer_load_dword v47, v35, s[32:35], s36 offen sc1
    s_branch K2_LOOPB
KB_10:
    v_cmp_eq_u32 vcc, 1, v47
    s_cmp_eq_u64 vcc, -1
    s_cbranch_scc1 PA_OK_19
    s_mov_b32 s82, 0
PA_SP_20:
    s_sleep 2
    buffer_load_dword v47, v35, s[32:35], s36 offen sc1
    s_add_u32 s82, s82, 1
    s_waitcnt vmcnt(0)
    v_cmp_eq_u32 vcc, 1, v47
    s_cmp_eq_u64 vcc, -1
    s_cbranch_scc1 PA_OK_19
    s_cmp_lt_u32 s82, 65536
    s_cbranch_scc1 PA_SP_20
PA_OK_19:
    buffer_load_dword v32, v45, s[32:35], s31 offen sc1
    buffer_load_dword v35, v45, s[32:35], s31 offen offset:64 sc1
    s_setprio 3
    v_exp_f32 v64, v64
    v_exp_f32 v65, v65
    s_waitcnt lgkmcnt(3)
    v_mfma_f32_32x32x16_bf16 v[96:111], v[28:31], v[124:127], v[96:111]
    ds_read_b128 v[28:31], v1 offset:3072
    s_mov_b32 m0, s72
    s_add_u32 s81, s70, s71
    s_add_u32 s72, s72, 16384
    buffer_load_dwordx4 v3, s[32:35], s81 offen sc1 lds
    v_exp_f32 v66, v66
    v_exp_f32 v67, v67
    v_exp_f32 v68, v68
    v_exp_f32 v69, v69
    s_waitcnt lgkmcnt(3)
    v_mfma_f32_32x32x16_bf16 v[80:95], v[16:19], v[8:11], v[48:63]
    ds_read_b128 v[16:19], v1 offset:8192
    v_exp_f32 v70, v70
    v_exp_f32 v71, v71
    v_cvt_pk_bf16_f32 v120, v64, v65
    v_cvt_pk_bf16_f32 v121, v66, v67
    v_mfma_f32_16x16x32_bf16 v[112:115], v[40:43], v[124:127], v[112:115]
    v_cvt_pk_bf16_f32 v122, v68, v69
    v_cvt_pk_bf16_f32 v123, v70, v71
    v_exp_f32 v72, v72
    s_waitcnt lgkmcnt(3)
    v_mfma_f32_32x32x16_bf16 v[80:95], v[20:23], v[12:15], v[80:95]
    ds_read_b128 v[20:23], v1 offset:9216
    buffer_load_dwordx4 v3, s[32:35], s81 offen offset:1024 sc1 lds
    s_and_b32 s72, s72, 65535
    s_add_u32 s71, s71, 16384
    s_and_b32 s71, s71, 0x3ffff
    v_exp_f32 v73, v73
    v_exp_f32 v74, v74
    v_exp_f32 v75, v75
    s_waitcnt lgkmcnt(3)
    v_mfma_f32_32x32x16_bf16 v[96:111], v[24:27], v[120:123], v[96:111]
    ds_read_b128 v[24:27], v1 offset:6144
    v_exp_f32 v76, v76
    v_exp_f32 v77, v77
    v_exp_f32 v78, v78
    v_mfma_f32_16x16x32_bf16 v[112:115], v[40:43], v[120:123], v[112:115]
    v_exp_f32 v79, v79
    v_cvt_pk_bf16_f32 v124, v72, v73
    v_cvt_pk_bf16_f32 v125, v74, v75
    v_cvt_pk_bf16_f32 v126, v76, v77
    v_cvt_pk_bf16_f32 v127, v78, v79
    buffer_load_dwordx4 v[128:131], v39, s[32:35], s28 offen offset:0 sc1
    s_setprio 2
    v_exp_f32 v80, v80
    v_exp_f32 v81, v81
    s_waitcnt lgkmcnt(3)
    v_mfma_f32_32x32x16_bf16 v[96:111], v[28:31], v[124:127], v[96:111]
    ds_read_b128 v[28:31], v1 offset:7168
    buffer_load_dwordx4 v[132:135], v39, s[32:35], s28 offen offset:256 sc1
    v_exp_f32 v82, v82
    v_exp_f32 v83, v83
    v_exp_f32 v84, v84
    v_exp_f32 v85, v85
    s_waitcnt lgkmcnt(3)
    v_mfma_f32_32x32x16_bf16 v[64:79], v[16:19], v[8:11], v[48:63]
    ds_read_b128 v[16:19], v1 offset:12288
    v_exp_f32 v86, v86
    v_exp_f32 v87, v87
    v_cvt_pk_bf16_f32 v120, v80, v81
    v_cvt_pk_bf16_f32 v121, v82, v83
    v_mfma_f32_16x16x32_bf16 v[112:115], v[40:43], v[124:127], v[112:115]
    v_cvt_pk_bf16_f32 v122, v84, v85
    v_cvt_pk_bf16_f32 v123, v86, v87
    v_exp_f32 v88, v88
    s_waitcnt lgkmcnt(3)
    v_mfma_f32_32x32x16_bf16 v[64:79], v[20:23], v[12:15], v[64:79]
    ds_read_b128 v[20:23], v1 offset:13312
    buffer_load_dwordx4 v[136:139], v39, s[32:35], s28 offen offset:2048 sc1
    v_exp_f32 v89, v89
    v_exp_f32 v90, v90
    v_exp_f32 v91, v91
    s_waitcnt lgkmcnt(3)
    v_mfma_f32_32x32x16_bf16 v[96:111], v[24:27], v[120:123], v[96:111]
    ds_read_b128 v[24:27], v1 offset:10240
    v_exp_f32 v92, v92
    v_exp_f32 v93, v93
    v_exp_f32 v94, v94
    v_mfma_f32_16x16x32_bf16 v[112:115], v[40:43], v[120:123], v[112:115]
    v_exp_f32 v95, v95
    v_cvt_pk_bf16_f32 v124, v88, v89
    v_cvt_pk_bf16_f32 v125, v90, v91
    v_cvt_pk_bf16_f32 v126, v92, v93
    v_cvt_pk_bf16_f32 v127, v94, v95
    s_setprio 1
    v_exp_f32 v64, v64
    v_exp_f32 v65, v65
    s_waitcnt lgkmcnt(3)
    v_mfma_f32_32x32x16_bf16 v[96:111], v[28:31], v[124:127], v[96:111]
    ds_read_b128 v[28:31], v1 offset:11264
    buffer_load_dwordx4 v[140:143], v39, s[32:35], s28 offen offset:2304 sc1
    s_add_u32 s28, s28, 4096
    v_exp_f32 v66, v66
    v_exp_f32 v67, v67
    v_exp_f32 v68, v68
    v_exp_f32 v69, v69
    s_waitcnt lgkmcnt(3)
    v_mfma_f32_32x32x16_bf16 v[80:95], v[16:19], v[8:11], v[48:63]
    ds_read_b128 v[16:19], v2 offset:0
    v_exp_f32 v70, v70
    v_exp_f32 v71, v71
    v_cvt_pk_bf16_f32 v120, v64, v65
    v_cvt_pk_bf16_f32 v121, v66, v67
    v_mfma_f32_16x16x32_bf16 v[112:115], v[40:43], v[124:127], v[112:115]
    v_cvt_pk_bf16_f32 v122, v68, v69
    v_cvt_pk_bf16_f32 v123, v70, v71
    v_exp_f32 v72, v72
    s_waitcnt lgkmcnt(3)
    v_mfma_f32_32x32x16_bf16 v[80:95], v[20:23], v[12:15], v[80:95]
    ds_read_b128 v[20:23], v2 offset:1024
    buffer_load_dwordx4 v[144:147], v39, s[32:35], s28 offen offset:0 sc1
    v_exp_f32 v73, v73
    v_exp_f32 v74, v74
    v_exp_f32 v75, v75
    s_waitcnt lgkmcnt(3)
    v_mfma_f32_32x32x16_bf16 v[96:111], v[24:27], v[120:123], v[96:111]
    ds_read_b128 v[24:27], v1 offset:14336
    v_exp_f32 v76, v76
    v_exp_f32 v77, v77
    v_exp_f32 v78, v78
    v_mfma_f32_16x16x32_bf16 v[112:115], v[40:43], v[120:123], v[112:115]
    v_exp_f32 v79, v79
    v_cvt_pk_bf16_f32 v124, v72, v73
    v_cvt_pk_bf16_f32 v125, v74, v75
    v_cvt_pk_bf16_f32 v126, v76, v77
    v_cvt_pk_bf16_f32 v127, v78, v79
    s_setprio 0
    v_exp_f32 v80, v80
    v_exp_f32 v81, v81
    s_waitcnt lgkmcnt(3)
    v_mfma_f32_32x32x16_bf16 v[96:111], v[28:31], v[124:127], v[96:111]
    ds_read_b128 v[28:31], v1 offset:15360
    buffer_load_dwordx4 v[148:151], v39, s[32:35], s28 offen offset:256 sc1
    v_exp_f32 v82, v82
    v_exp_f32 v83, v83
    v_exp_f32 v84, v84
    v_exp_f32 v85, v85
    s_waitcnt lgkmcnt(3)
    v_mfma_f32_32x32x16_bf16 v[64:79], v[16:19], v[8:11], v[48:63]
    ds_read_b128 v[16:19], v2 offset:4096
    v_exp_f32 v86, v86
    v_exp_f32 v87, v87
    v_cvt_pk_bf16_f32 v120, v80, v81
    v_cvt_pk_bf16_f32 v121, v82, v83
    v_mfma_f32_16x16x32_bf16 v[112:115], v[40:43], v[124:127], v[112:115]
    v_cvt_pk_bf16_f32 v122, v84, v85
    v_cvt_pk_bf16_f32 v123, v86, v87
    v_exp_f32 v88, v88
    s_waitcnt lgkmcnt(3)
    v_mfma_f32_32x32x16_bf16 v[64:79], v[20:23], v[12:15], v[64:79]
    ds_read_b128 v[20:23], v2 offset:5120
    v_exp_f32 v89, v89
    v_exp_f32 v90, v90
    v_exp_f32 v91, v91
    s_waitcnt lgkmcnt(3)
    v_mfma_f32_32x32x16_bf16 v[96:111], v[24:27], v[120:123], v[96:111]
    ds_read_b128 v[24:27], v2 offset:2048
    v_exp_f32 v92, v92
    v_exp_f32 v93, v93
    v_exp_f32 v94, v94
    v_mfma_f32_16x16x32_bf16 v[112:115], v[40:43], v[120:123], v[112:115]
    v_exp_f32 v95, v95
    v_cvt_pk_bf16_f32 v124, v88, v89
    v_cvt_pk_bf16_f32 v125, v90, v91
    v_cvt_pk_bf16_f32 v126, v92, v93
    v_cvt_pk_bf16_f32 v127, v94, v95
    v_mov_b32 v1, v2
    v_add_u32 v2, 16384, v2
    v_and_b32 v2, 65535, v2
    s_waitcnt vmcnt(10)
    s_barrier
    s_setprio 3
    v_exp_f32 v64, v64
    v_exp_f32 v65, v65
    s_waitcnt lgkmcnt(3)
    v_mfma_f32_32x32x16_bf16 v[96:111], v[28:31], v[124:127], v[96:111]
    ds_read_b128 v[28:31], v1 offset:3072
    s_mov_b32 m0, s72
    s_add_u32 s81, s70, s71
    s_add_u32 s72, s72, 16384
    buffer_load_dwordx4 v3, s[32:35], s81 offen sc1 lds
    v_exp_f32 v66, v66
    v_exp_f32 v67, v67
    v_exp_f32 v68, v68
    v_exp_f32 v69, v69
    s_waitcnt lgkmcnt(3)
    v_mfma_f32_32x32x16_bf16 v[80:95], v[16:19], v[8:11], v[48:63]
    ds_read_b128 v[16:19], v1 offset:8192
    v_exp_f32 v70, v70
    v_exp_f32 v71, v71
    v_cvt_pk_bf16_f32 v120, v64, v65
    v_cvt_pk_bf16_f32 v121, v66, v67
    v_mfma_f32_16x16x32_bf16 v[112:115], v[40:43], v[124:127], v[112:115]
    v_cvt_pk_bf16_f32 v122, v68, v69
    v_cvt_pk_bf16_f32 v123, v70, v71
    v_exp_f32 v72, v72
    s_waitcnt lgkmcnt(3)
    v_mfma_f32_32x32x16_bf16 v[80:95], v[20:23], v[12:15], v[80:95]
    ds_read_b128 v[20:23], v1 offset:9216
    buffer_load_dwordx4 v3, s[32:35], s81 offen offset:1024 sc1 lds
    s_and_b32 s72, s72, 65535
    s_add_u32 s71, s71, 16384
    s_and_b32 s71, s71, 0x3ffff
    v_exp_f32 v73, v73
    v_exp_f32 v74, v74
    v_exp_f32 v75, v75
    s_waitcnt lgkmcnt(3)
    v_mfma_f32_32x32x16_bf16 v[96:111], v[24:27], v[120:123], v[96:111]
    ds_read_b128 v[24:27], v1 offset:6144
    v_exp_f32 v76, v76
    v_exp_f32 v77, v77
    v_exp_f32 v78, v78
    v_mfma_f32_16x16x32_bf16 v[112:115], v[40:43], v[120:123], v[112:115]
    v_exp_f32 v79, v79
    v_cvt_pk_bf16_f32 v124, v72, v73
    v_cvt_pk_bf16_f32 v125, v74, v75
    v_cvt_pk_bf16_f32 v126, v76, v77
    v_cvt_pk_bf16_f32 v127, v78, v79
    buffer_load_dwordx4 v[152:155], v39, s[32:35], s28 offen offset:2048 sc1
    s_setprio 2
    v_exp_f32 v80, v80
    v_exp_f32 v81, v81
    s_waitcnt lgkmcnt(3)
    v_mfma_f32_32x32x16_bf16 v[96:111], v[28:31], v[124:127], v[96:111]
    ds_read_b128 v[28:31], v1 offset:7168
    buffer_load_dwordx4 v[156:159], v39, s[32:35], s28 offen offset:2304 sc1
    s_add_u32 s28, s28, 4096
    v_exp_f32 v82, v82
    v_exp_f32 v83, v83
    v_exp_f32 v84, v84
    v_exp_f32 v85, v85
    s_waitcnt lgkmcnt(3)
    v_mfma_f32_32x32x16_bf16 v[64:79], v[16:19], v[8:11], v[48:63]
    ds_read_b128 v[16:19], v1 offset:12288
    v_exp_f32 v86, v86
    v_exp_f32 v87, v87
    v_cvt_pk_bf16_f32 v120, v80, v81
    v_cvt_pk_bf16_f32 v121, v82, v83
    v_mfma_f32_16x16x32_bf16 v[112:115], v[40:43], v[124:127], v[112:115]
    v_cvt_pk_bf16_f32 v122, v84, v85
    v_cvt_pk_bf16_f32 v123, v86, v87
    v_exp_f32 v88, v88
    s_waitcnt lgkmcnt(3)
    v_mfma_f32_32x32x16_bf16 v[64:79], v[20:23], v[12:15], v[64:79]
    ds_read_b128 v[20:23], v1 offset:13312
    buffer_load_dwordx4 v[160:163], v39, s[32:35], s28 offen offset:0 sc1
    v_exp_f32 v89, v89
    v_exp_f32 v90, v90
    v_exp_f32 v91, v91
    s_waitcnt lgkmcnt(3)
    v_mfma_f32_32x32x16_bf16 v[96:111], v[24:27], v[120:123], v[96:111]
    ds_read_b128 v[24:27], v1 offset:10240
    v_exp_f32 v92, v92
    v_exp_f32 v93, v93
    v_exp_f32 v94, v94
    v_mfma_f32_16x16x32_bf16 v[112:115], v[40:43], v[120:123], v[112:115]
    v_exp_f32 v95, v95
    v_cvt_pk_bf16_f32 v124, v88, v89
    v_cvt_pk_bf16_f32 v125, v90, v91
    v_cvt_pk_bf16_f32 v126, v92, v93
    v_cvt_pk_bf16_f32 v127, v94, v95
    s_setprio 1
    v_exp_f32 v64, v64
    v_exp_f32 v65, v65
    s_waitcnt lgkmcnt(3)
    v_mfma_f32_32x32x16_bf16 v[96:111], v[28:31], v[124:127], v[96:111]
    ds_read_b128 v[28:31], v1 offset:11264
    buffer_load_dwordx4 v[164:167], v39, s[32:35], s28 offen offset:256 sc1
    v_exp_f32 v66, v66
    v_exp_f32 v67, v67
    v_exp_f32 v68, v68
    v_exp_f32 v69, v69
    s_waitcnt lgkmcnt(3)
    v_mfma_f32_32x32x16_bf16 v[80:95], v[16:19], v[8:11], v[48:63]
    ds_read_b128 v[16:19], v2 offset:0
    v_exp_f32 v70, v70
    v_exp_f32 v71, v71
    v_cvt_pk_bf16_f32 v120, v64, v65
    v_cvt_pk_bf16_f32 v121, v66, v67
    v_mfma_f32_16x16x32_bf16 v[112:115], v[40:43], v[124:127], v[112:115]
    v_cvt_pk_bf16_f32 v122, v68, v69
    v_cvt_pk_bf16_f32 v123, v70, v71
    v_exp_f32 v72, v72
    s_waitcnt lgkmcnt(3)
    v_mfma_f32_32x32x16_bf16 v[80:95], v[20:23], v[12:15], v[80:95]
    ds_read_b128 v[20:23], v2 offset:1024
    buffer_load_dwordx4 v[168:171], v39, s[32:35], s28 offen offset:2048 sc1
    v_exp_f32 v73, v73
    v_exp_f32 v74, v74
    v_exp_f32 v75, v75
    s_waitcnt lgkmcnt(3)
    v_mfma_f32_32x32x16_bf16 v[96:111], v[24:27], v[120:123], v[96:111]
    ds_read_b128 v[24:27], v1 offset:14336
    v_exp_f32 v76, v76
    v_exp_f32 v77, v77
    v_exp_f32 v78, v78
    v_mfma_f32_16x16x32_bf16 v[112:115], v[40:43], v[120:123], v[112:115]
    v_exp_f32 v79, v79
    v_cvt_pk_bf16_f32 v124, v72, v73
    v_cvt_pk_bf16_f32 v125, v74, v75
    v_cvt_pk_bf16_f32 v126, v76, v77
    v_cvt_pk_bf16_f32 v127, v78, v79
    s_setprio 0
    v_exp_f32 v80, v80
    v_exp_f32 v81, v81
    s_waitcnt lgkmcnt(3)
    v_mfma_f32_32x32x16_bf16 v[96:111], v[28:31], v[124:127], v[96:111]
    ds_read_b128 v[28:31], v1 offset:15360
    buffer_load_dwordx4 v[172:175], v39, s[32:35], s28 offen offset:2304 sc1
    s_add_u32 s28, s28, 4096
    v_exp_f32 v82, v82
    v_exp_f32 v83, v83
    v_exp_f32 v84, v84
    v_exp_f32 v85, v85
    s_waitcnt lgkmcnt(3)
    v_mfma_f32_32x32x16_bf16 v[64:79], v[16:19], v[8:11], v[48:63]
    ds_read_b128 v[16:19], v2 offset:4096
    v_exp_f32 v86, v86
    v_exp_f32 v87, v87
    v_cvt_pk_bf16_f32 v120, v80, v81
    v_cvt_pk_bf16_f32 v121, v82, v83
    v_mfma_f32_16x16x32_bf16 v[112:115], v[40:43], v[124:127], v[112:115]
    v_cvt_pk_bf16_f32 v122, v84, v85
    v_cvt_pk_bf16_f32 v123, v86, v87
    v_exp_f32 v88, v88
    s_waitcnt lgkmcnt(3)
    v_mfma_f32_32x32x16_bf16 v[64:79], v[20:23], v[12:15], v[64:79]
    ds_read_b128 v[20:23], v2 offset:5120
    v_exp_f32 v89, v89
    v_exp_f32 v90, v90
    v_exp_f32 v91, v91
    s_waitcnt lgkmcnt(3)
    v_mfma_f32_32x32x16_bf16 v[96:111], v[24:27], v[120:123], v[96:111]
    ds_read_b128 v[24:27], v2 offset:2048
    v_exp_f32 v92, v92
    v_exp_f32 v93, v93
    v_exp_f32 v94, v94
    v_mfma_f32_16x16x32_bf16 v[112:115], v[40:43], v[120:123], v[112:115]
    v_exp_f32 v95, v95
    v_cvt_pk_bf16_f32 v124, v88, v89
    v_cvt_pk_bf16_f32 v125, v90, v91
    v_cvt_pk_bf16_f32 v126, v92, v93
    v_cvt_pk_bf16_f32 v127, v94, v95
    v_mov_b32 v1, v2
    v_add_u32 v2, 16384, v2
    v_and_b32 v2, 65535, v2
    s_waitcnt vmcnt(14)
    s_barrier
    s_setprio 3
    v_exp_f32 v64, v64
    v_exp_f32 v65, v65
    s_waitcnt lgkmcnt(3)
    v_mfma_f32_32x32x16_bf16 v[96:111], v[28:31], v[124:127], v[96:111]
    ds_read_b128 v[28:31], v1 offset:3072
    s_mov_b32 m0, s72
    s_add_u32 s81, s70, s71
    s_add_u32 s72, s72, 16384
    buffer_load_dwordx4 v3, s[32:35], s81 offen sc1 lds
    v_exp_f32 v66, v66
    v_exp_f32 v67, v67
    v_exp_f32 v68, v68
    v_exp_f32 v69, v69
    s_waitcnt lgkmcnt(3)
    v_mfma_f32_32x32x16_bf16 v[80:95], v[16:19], v[8:11], v[48:63]
    ds_read_b128 v[16:19], v1 offset:8192
    v_exp_f32 v70, v70
    v_exp_f32 v71, v71
    v_cvt_pk_bf16_f32 v120, v64, v65
    v_cvt_pk_bf16_f32 v121, v66, v67
    v_mfma_f32_16x16x32_bf16 v[112:115], v[40:43], v[124:127], v[112:115]
    v_cvt_pk_bf16_f32 v122, v68, v69
    v_cvt_pk_bf16_f32 v123, v70, v71
    v_exp_f32 v72, v72
    s_waitcnt lgkmcnt(3)
    v_mfma_f32_32x32x16_bf16 v[80:95], v[20:23], v[12:15], v[80:95]
    ds_read_b128 v[20:23], v1 offset:9216
    buffer_load_dwordx4 v3, s[32:35], s81 offen offset:1024 sc1 lds
    s_and_b32 s72, s72, 65535
    s_add_u32 s71, s71, 16384
    s_and_b32 s71, s71, 0x3ffff
    v_exp_f32 v73, v73
    v_exp_f32 v74, v74
    v_exp_f32 v75, v75
    s_waitcnt lgkmcnt(3)
    v_mfma_f32_32x32x16_bf16 v[96:111], v[24:27], v[120:123], v[96:111]
    ds_read_b128 v[24:27], v1 offset:6144
    v_exp_f32 v76, v76
    v_exp_f32 v77, v77
    v_exp_f32 v78, v78
    v_mfma_f32_16x16x32_bf16 v[112:115], v[40:43], v[120:123], v[112:115]
    v_exp_f32 v79, v79
    v_cvt_pk_bf16_f32 v124, v72, v73
    v_cvt_pk_bf16_f32 v125, v74, v75
    v_cvt_pk_bf16_f32 v126, v76, v77
    v_cvt_pk_bf16_f32 v127, v78, v79
    buffer_load_dwordx4 v[176:179], v39, s[32:35], s28 offen offset:0 sc1
    s_setprio 2
    v_exp_f32 v80, v80
    v_exp_f32 v81, v81
    s_waitcnt lgkmcnt(3)
    v_mfma_f32_32x32x16_bf16 v[96:111], v[28:31], v[124:127], v[96:111]
    ds_read_b128 v[28:31], v1 offset:7168
    buffer_load_dwordx4 v[180:183], v39, s[32:35], s28 offen offset:256 sc1
    v_exp_f32 v82, v82
    v_exp_f32 v83, v83
    v_exp_f32 v84, v84
    v_exp_f32 v85, v85
    s_waitcnt lgkmcnt(3)
    v_mfma_f32_32x32x16_bf16 v[64:79], v[16:19], v[8:11], v[48:63]
    ds_read_b128 v[16:19], v1 offset:12288
    v_exp_f32 v86, v86
    v_exp_f32 v87, v87
    v_cvt_pk_bf16_f32 v120, v80, v81
    v_cvt_pk_bf16_f32 v121, v82, v83
    v_mfma_f32_16x16x32_bf16 v[112:115], v[40:43], v[124:127], v[112:115]
    v_cvt_pk_bf16_f32 v122, v84, v85
    v_cvt_pk_bf16_f32 v123, v86, v87
    v_exp_f32 v88, v88
    s_waitcnt lgkmcnt(3)
    v_mfma_f32_32x32x16_bf16 v[64:79], v[20:23], v[12:15], v[64:79]
    ds_read_b128 v[20:23], v1 offset:13312
    buffer_load_dwordx4 v[184:187], v39, s[32:35], s28 offen offset:2048 sc1
    v_exp_f32 v89, v89
    v_exp_f32 v90, v90
    v_exp_f32 v91, v91
    s_waitcnt lgkmcnt(3)
    v_mfma_f32_32x32x16_bf16 v[96:111], v[24:27], v[120:123], v[96:111]
    ds_read_b128 v[24:27], v1 offset:10240
    v_exp_f32 v92, v92
    v_exp_f32 v93, v93
    v_exp_f32 v94, v94
    v_mfma_f32_16x16x32_bf16 v[112:115], v[40:43], v[120:123], v[112:115]
    v_exp_f32 v95, v95
    v_cvt_pk_bf16_f32 v124, v88, v89
    v_cvt_pk_bf16_f32 v125, v90, v91
    v_cvt_pk_bf16_f32 v126, v92, v93
    v_cvt_pk_bf16_f32 v127, v94, v95
    s_setprio 1
    v_exp_f32 v64, v64
    v_exp_f32 v65, v65
    s_waitcnt lgkmcnt(3)
    v_mfma_f32_32x32x16_bf16 v[96:111], v[28:31], v[124:127], v[96:111]
    ds_read_b128 v[28:31], v1 offset:11264
    buffer_load_dwordx4 v[188:191], v39, s[32:35], s28 offen offset:2304 sc1
    s_add_u32 s28, s28, 4096
    v_exp_f32 v66, v66
    v_exp_f32 v67, v67
    v_exp_f32 v68, v68
    v_exp_f32 v69, v69
    s_waitcnt lgkmcnt(3)
    v_mfma_f32_32x32x16_bf16 v[80:95], v[16:19], v[8:11], v[48:63]
    ds_read_b128 v[16:19], v2 offset:0
    v_exp_f32 v70, v70
    v_exp_f32 v71, v71
    v_cvt_pk_bf16_f32 v120, v64, v65
    v_cvt_pk_bf16_f32 v121, v66, v67
    v_mfma_f32_16x16x32_bf16 v[112:115], v[40:43], v[124:127], v[112:115]
    v_cvt_pk_bf16_f32 v122, v68, v69
    v_cvt_pk_bf16_f32 v123, v70, v71
    v_exp_f32 v72, v72
    s_waitcnt lgkmcnt(3)
    v_mfma_f32_32x32x16_bf16 v[80:95], v[20:23], v[12:15], v[80:95]
    ds_read_b128 v[20:23], v2 offset:1024
    buffer_load_dwordx4 v[192:195], v39, s[32:35], s28 offen offset:0 sc1
    v_exp_f32 v73, v73
    v_exp_f32 v74, v74
    v_exp_f32 v75, v75
    s_waitcnt lgkmcnt(3)
    v_mfma_f32_32x32x16_bf16 v[96:111], v[24:27], v[120:123], v[96:111]
    ds_read_b128 v[24:27], v1 offset:14336
    v_exp_f32 v76, v76
    v_exp_f32 v77, v77
    v_exp_f32 v78, v78
    v_mfma_f32_16x16x32_bf16 v[112:115], v[40:43], v[120:123], v[112:115]
    v_exp_f32 v79, v79
    v_cvt_pk_bf16_f32 v124, v72, v73
    v_cvt_pk_bf16_f32 v125, v74, v75
    v_cvt_pk_bf16_f32 v126, v76, v77
    v_cvt_pk_bf16_f32 v127, v78, v79
    s_setprio 0
    v_exp_f32 v80, v80
    v_exp_f32 v81, v81
    s_waitcnt lgkmcnt(3)
    v_mfma_f32_32x32x16_bf16 v[96:111], v[28:31], v[124:127], v[96:111]
    ds_read_b128 v[28:31], v1 offset:15360
    buffer_load_dwordx4 v[196:199], v39, s[32:35], s28 offen offset:256 sc1
    v_exp_f32 v82, v82
    v_exp_f32 v83, v83
    v_exp_f32 v84, v84
    v_exp_f32 v85, v85
    s_waitcnt lgkmcnt(3)
    v_mfma_f32_32x32x16_bf16 v[64:79], v[16:19], v[8:11], v[48:63]
    ds_read_b128 v[16:19], v2 offset:4096
    v_exp_f32 v86, v86
    v_exp_f32 v87, v87
    v_cvt_pk_bf16_f32 v120, v80, v81
    v_cvt_pk_bf16_f32 v121, v82, v83
    v_mfma_f32_16x16x32_bf16 v[112:115], v[40:43], v[124:127], v[112:115]
    v_cvt_pk_bf16_f32 v122, v84, v85
    v_cvt_pk_bf16_f32 v123, v86, v87
    v_exp_f32 v88, v88
    s_waitcnt lgkmcnt(3)
    v_mfma_f32_32x32x16_bf16 v[64:79], v[20:23], v[12:15], v[64:79]
    ds_read_b128 v[20:23], v2 offset:5120
    v_exp_f32 v89, v89
    v_exp_f32 v90, v90
    v_exp_f32 v91, v91
    s_waitcnt lgkmcnt(3)
    v_mfma_f32_32x32x16_bf16 v[96:111], v[24:27], v[120:123], v[96:111]
    ds_read_b128 v[24:27], v2 offset:2048
    v_exp_f32 v92, v92
    v_exp_f32 v93, v93
    v_exp_f32 v94, v94
    v_mfma_f32_16x16x32_bf16 v[112:115], v[40:43], v[120:123], v[112:115]
    v_exp_f32 v95, v95
    v_cvt_pk_bf16_f32 v124, v88, v89
    v_cvt_pk_bf16_f32 v125, v90, v91
    v_cvt_pk_bf16_f32 v126, v92, v93
    v_cvt_pk_bf16_f32 v127, v94, v95
    s_and_b32 s47, s16, 3
    s_lshl_b32 s47, s47, 3
    s_add_u32 s47, s47, s40
    s_lshl_b32 s47, s47, 5
    v_add_u32 v44, s47, v0
    v_lshlrev_b32 v44, 11, v44
    s_lshl_b32 s47, s17, 7
    v_add_u32 v44, s47, v44
    v_mov_b32 v4, 0x7ffffff0
    v_cmp_gt_u32 vcc, 32, v0
    s_mov_b32 s92, s6
    s_mov_b32 s93, s7
    s_mov_b32 s94, 2097152
    s_mov_b32 s95, 0x00020000
    v_cndmask_b32 v44, v4, v44, vcc
    buffer_load_dword v44, v44, s[92:95], 0 offen
    v_mov_b32 v1, v2
    v_add_u32 v2, 16384, v2
    v_and_b32 v2, 65535, v2
    s_waitcnt vmcnt(15)
    s_barrier
    s_setprio 3
    v_exp_f32 v64, v64
    v_exp_f32 v65, v65
    s_waitcnt lgkmcnt(3)
    v_mfma_f32_32x32x16_bf16 v[96:111], v[28:31], v[124:127], v[96:111]
    ds_read_b128 v[28:31], v1 offset:3072
    s_add_u32 m0, s30, 0
    s_nop 0
    buffer_load_dwordx4 v36, s[20:23], s29 offen lds
    v_exp_f32 v66, v66
    v_exp_f32 v67, v67
    v_exp_f32 v68, v68
    v_exp_f32 v69, v69
    s_waitcnt lgkmcnt(3)
    v_mfma_f32_32x32x16_bf16 v[80:95], v[16:19], v[8:11], v[48:63]
    ds_read_b128 v[16:19], v1 offset:8192
    v_exp_f32 v70, v70
    v_exp_f32 v71, v71
    v_cvt_pk_bf16_f32 v120, v64, v65
    v_cvt_pk_bf16_f32 v121, v66, v67
    v_mfma_f32_16x16x32_bf16 v[112:115], v[40:43], v[124:127], v[112:115]
    v_cvt_pk_bf16_f32 v122, v68, v69
    v_cvt_pk_bf16_f32 v123, v70, v71
    v_exp_f32 v72, v72
    s_waitcnt lgkmcnt(3)
    v_mfma_f32_32x32x16_bf16 v[80:95], v[20:23], v[12:15], v[80:95]
    ds_read_b128 v[20:23], v1 offset:9216
    buffer_load_dwordx4 v37, s[20:23], s29 offen offset:1024 lds
    s_add_u32 s29, s29, 131072
    v_exp_f32 v73, v73
    v_exp_f32 v74, v74
    v_exp_f32 v75, v75
    s_waitcnt lgkmcnt(3)
    v_mfma_f32_32x32x16_bf16 v[96:111], v[24:27], v[120:123], v[96:111]
    ds_read_b128 v[24:27], v1 offset:6144
    v_exp_f32 v76, v76
    v_exp_f32 v77, v77
    v_exp_f32 v78, v78
    v_mfma_f32_16x16x32_bf16 v[112:115], v[40:43], v[120:123], v[112:115]
    v_exp_f32 v79, v79
    v_cvt_pk_bf16_f32 v124, v72, v73
    v_cvt_pk_bf16_f32 v125, v74, v75
    v_cvt_pk_bf16_f32 v126, v76, v77
    v_cvt_pk_bf16_f32 v127, v78, v79
    buffer_load_dwordx4 v[200:203], v39, s[32:35], s28 offen offset:2048 sc1
    s_setprio 2
    v_exp_f32 v80, v80
    v_exp_f32 v81, v81
    s_waitcnt lgkmcnt(3)
    v_mfma_f32_32x32x16_bf16 v[96:111], v[28:31], v[124:127], v[96:111]
    ds_read_b128 v[28:31], v1 offset:7168
    buffer_load_dwordx4 v[204:207], v39, s[32:35], s28 offen offset:2304 sc1
    s_add_u32 s28, s28, 4096
    v_exp_f32 v82, v82
    v_exp_f32 v83, v83
    v_exp_f32 v84, v84
    v_exp_f32 v85, v85
    s_waitcnt lgkmcnt(3)
    v_mfma_f32_32x32x16_bf16 v[64:79], v[16:19], v[8:11], v[48:63]
    ds_read_b128 v[16:19], v1 offset:12288
    v_exp_f32 v86, v86
    v_exp_f32 v87, v87
    v_cvt_pk_bf16_f32 v120, v80, v81
    v_cvt_pk_bf16_f32 v121, v82, v83
    v_mfma_f32_16x16x32_bf16 v[112:115], v[40:43], v[124:127], v[112:115]
    v_cvt_pk_bf16_f32 v122, v84, v85
    v_cvt_pk_bf16_f32 v123, v86, v87
    v_exp_f32 v88, v88
    s_waitcnt lgkmcnt(3)
    v_mfma_f32_32x32x16_bf16 v[64:79], v[20:23], v[12:15], v[64:79]
    ds_read_b128 v[20:23], v1 offset:13312
    buffer_load_dwordx4 v[208:211], v39, s[32:35], s28 offen offset:0 sc1
    v_exp_f32 v89, v89
    v_exp_f32 v90, v90
    v_exp_f32 v91, v91
    s_waitcnt lgkmcnt(3)
    v_mfma_f32_32x32x16_bf16 v[96:111], v[24:27], v[120:123], v[96:111]
    ds_read_b128 v[24:27], v1 offset:10240
    v_exp_f32 v92, v92
    v_exp_f32 v93, v93
    v_exp_f32 v94, v94
    v_mfma_f32_16x16x32_bf16 v[112:115], v[40:43], v[120:123], v[112:115]
    v_exp_f32 v95, v95
    v_cvt_pk_bf16_f32 v124, v88, v89
    v_cvt_pk_bf16_f32 v125, v90, v91
    v_cvt_pk_bf16_f32 v126, v92, v93
    v_cvt_pk_bf16_f32 v127, v94, v95
    s_setprio 1
    v_exp_f32 v64, v64
    v_exp_f32 v65, v65
    s_waitcnt lgkmcnt(3)
    v_mfma_f32_32x32x16_bf16 v[96:111], v[28:31], v[124:127], v[96:111]
    ds_read_b128 v[28:31], v1 offset:11264
    buffer_load_dwordx4 v[212:215], v39, s[32:35], s28 offen offset:256 sc1
    v_exp_f32 v66, v66
    v_exp_f32 v67, v67
    v_exp_f32 v68, v68
    v_exp_f32 v69, v69
    s_waitcnt lgkmcnt(3)
    v_mfma_f32_32x32x16_bf16 v[80:95], v[16:19], v[8:11], v[48:63]
    ds_read_b128 v[16:19], v2 offset:0
    v_exp_f32 v70, v70
    v_exp_f32 v71, v71
    v_cvt_pk_bf16_f32 v120, v64, v65
    v_cvt_pk_bf16_f32 v121, v66, v67
    v_mfma_f32_16x16x32_bf16 v[112:115], v[40:43], v[124:127], v[112:115]
    v_cvt_pk_bf16_f32 v122, v68, v69
    v_cvt_pk_bf16_f32 v123, v70, v71
    v_exp_f32 v72, v72
    s_waitcnt lgkmcnt(3)
    v_mfma_f32_32x32x16_bf16 v[80:95], v[20:23], v[12:15], v[80:95]
    ds_read_b128 v[20:23], v2 offset:1024
    v_exp_f32 v73, v73
    v_exp_f32 v74, v74
    v_exp_f32 v75, v75
    s_waitcnt lgkmcnt(3)
    v_mfma_f32_32x32x16_bf16 v[96:111], v[24:27], v[120:123], v[96:111]
    ds_read_b128 v[24:27], v1 offset:14336
    v_exp_f32 v76, v76
    v_exp_f32 v77, v77
    v_exp_f32 v78, v78
    v_mfma_f32_16x16x32_bf16 v[112:115], v[40:43], v[120:123], v[112:115]
    v_exp_f32 v79, v79
    v_cvt_pk_bf16_f32 v124, v72, v73
    v_cvt_pk_bf16_f32 v125, v74, v75
    v_cvt_pk_bf16_f32 v126, v76, v77
    v_cvt_pk_bf16_f32 v127, v78, v79
    s_setprio 0
    v_exp_f32 v80, v80
    v_exp_f32 v81, v81
    s_waitcnt lgkmcnt(3)
    v_mfma_f32_32x32x16_bf16 v[96:111], v[28:31], v[124:127], v[96:111]
    ds_read_b128 v[28:31], v1 offset:15360
    buffer_load_dwordx4 v[216:219], v39, s[32:35], s28 offen offset:2048 sc1
    v_exp_f32 v82, v82
    v_exp_f32 v83, v83
    v_exp_f32 v84, v84
    v_exp_f32 v85, v85
    s_waitcnt lgkmcnt(3)
    v_mfma_f32_32x32x16_bf16 v[64:79], v[16:19], v[8:11], v[48:63]
    ds_read_b128 v[16:19], v2 offset:4096
    v_exp_f32 v86, v86
    v_exp_f32 v87, v87
    v_cvt_pk_bf16_f32 v120, v80, v81
    v_cvt_pk_bf16_f32 v121, v82, v83
    v_mfma_f32_16x16x32_bf16 v[112:115], v[40:43], v[124:127], v[112:115]
    v_cvt_pk_bf16_f32 v122, v84, v85
    v_cvt_pk_bf16_f32 v123, v86, v87
    v_exp_f32 v88, v88
    s_waitcnt lgkmcnt(3)
    v_mfma_f32_32x32x16_bf16 v[64:79], v[20:23], v[12:15], v[64:79]
    ds_read_b128 v[20:23], v2 offset:5120
    v_exp_f32 v89, v89
    v_exp_f32 v90, v90
    v_exp_f32 v91, v91
    s_waitcnt lgkmcnt(3)
    v_mfma_f32_32x32x16_bf16 v[96:111], v[24:27], v[120:123], v[96:111]
    ds_read_b128 v[24:27], v2 offset:2048
    v_exp_f32 v92, v92
    v_exp_f32 v93, v93
    v_exp_f32 v94, v94
    v_mfma_f32_16x16x32_bf16 v[112:115], v[40:43], v[120:123], v[112:115]
    v_exp_f32 v95, v95
    v_cvt_pk_bf16_f32 v124, v88, v89
    v_cvt_pk_bf16_f32 v125, v90, v91
    v_cvt_pk_bf16_f32 v126, v92, v93
    v_cvt_pk_bf16_f32 v127, v94, v95
    v_mov_b32 v1, v2
    v_add_u32 v2, 16384, v2
    v_and_b32 v2, 65535, v2
    s_waitcnt vmcnt(14)
    s_barrier
    s_setprio 3
    v_exp_f32 v64, v64
    v_exp_f32 v65, v65
    s_waitcnt lgkmcnt(3)
    v_mfma_f32_32x32x16_bf16 v[96:111], v[28:31], v[124:127], v[96:111]
    ds_read_b128 v[28:31], v1 offset:3072
    s_add_u32 m0, s30, 16384
    s_nop 0
    buffer_load_dwordx4 v36, s[20:23], s29 offen lds
    v_exp_f32 v66, v66
    v_exp_f32 v67, v67
    v_exp_f32 v68, v68
    v_exp_f32 v69, v69
    s_waitcnt lgkmcnt(3)
    v_mfma_f32_32x32x16_bf16 v[80:95], v[16:19], v[8:11], v[48:63]
    ds_read_b128 v[16:19], v1 offset:8192
    v_exp_f32 v70, v70
    v_exp_f32 v71, v71
    v_cvt_pk_bf16_f32 v120, v64, v65
    v_cvt_pk_bf16_f32 v121, v66, v67
    v_mfma_f32_16x16x32_bf16 v[112:115], v[40:43], v[124:127], v[112:115]
    v_cvt_pk_bf16_f32 v122, v68, v69
    v_cvt_pk_bf16_f32 v123, v70, v71
    v_exp_f32 v72, v72
    s_waitcnt lgkmcnt(3)
    v_mfma_f32_32x32x16_bf16 v[80:95], v[20:23], v[12:15], v[80:95]
    ds_read_b128 v[20:23], v1 offset:9216
    buffer_load_dwordx4 v37, s[20:23], s29 offen offset:1024 lds
    s_add_u32 s29, s29, 131072
    v_exp_f32 v73, v73
    v_exp_f32 v74, v74
    v_exp_f32 v75, v75
    s_waitcnt lgkmcnt(3)
    v_mfma_f32_32x32x16_bf16 v[96:111], v[24:27], v[120:123], v[96:111]
    ds_read_b128 v[24:27], v1 offset:6144
    v_exp_f32 v76, v76
    v_exp_f32 v77, v77
    v_exp_f32 v78, v78
    v_mfma_f32_16x16x32_bf16 v[112:115], v[40:43], v[120:123], v[112:115]
    v_exp_f32 v79, v79
    v_cvt_pk_bf16_f32 v124, v72, v73
    v_cvt_pk_bf16_f32 v125, v74, v75
    v_cvt_pk_bf16_f32 v126, v76, v77
    v_cvt_pk_bf16_f32 v127, v78, v79
    buffer_load_dwordx4 v[220:223], v39, s[32:35], s28 offen offset:2304 sc1
    s_add_u32 s28, s28, 4096
    s_setprio 2
    v_exp_f32 v80, v80
    v_exp_f32 v81, v81
    s_waitcnt lgkmcnt(3)
    v_mfma_f32_32x32x16_bf16 v[96:111], v[28:31], v[124:127], v[96:111]
    ds_read_b128 v[28:31], v1 offset:7168
    buffer_load_dwordx4 v[224:227], v39, s[32:35], s28 offen offset:0 sc1
    v_exp_f32 v82, v82
    v_exp_f32 v83, v83
    v_exp_f32 v84, v84
    v_exp_f32 v85, v85
    s_waitcnt lgkmcnt(3)
    v_mfma_f32_32x32x16_bf16 v[64:79], v[16:19], v[8:11], v[48:63]
    ds_read_b128 v[16:19], v1 offset:12288
    v_exp_f32 v86, v86
    v_exp_f32 v87, v87
    v_cvt_pk_bf16_f32 v120, v80, v81
    v_cvt_pk_bf16_f32 v121, v82, v83
    v_mfma_f32_16x16x32_bf16 v[112:115], v[40:43], v[124:127], v[112:115]
    v_cvt_pk_bf16_f32 v122, v84, v85
    v_cvt_pk_bf16_f32 v123, v86, v87
    v_exp_f32 v88, v88
    s_waitcnt lgkmcnt(3)
    v_mfma_f32_32x32x16_bf16 v[64:79], v[20:23], v[12:15], v[64:79]
    ds_read_b128 v[20:23], v1 offset:13312
    buffer_load_dwordx4 v[228:231], v39, s[32:35], s28 offen offset:256 sc1
    v_exp_f32 v89, v89
    v_exp_f32 v90, v90
    v_exp_f32 v91, v91
    s_waitcnt lgkmcnt(3)
    v_mfma_f32_32x32x16_bf16 v[96:111], v[24:27], v[120:123], v[96:111]
    ds_read_b128 v[24:27], v1 offset:10240
    v_exp_f32 v92, v92
    v_exp_f32 v93, v93
    v_exp_f32 v94, v94
    v_mfma_f32_16x16x32_bf16 v[112:115], v[40:43], v[120:123], v[112:115]
    v_exp_f32 v95, v95
    v_cvt_pk_bf16_f32 v124, v88, v89
    v_cvt_pk_bf16_f32 v125, v90, v91
    v_cvt_pk_bf16_f32 v126, v92, v93
    v_cvt_pk_bf16_f32 v127, v94, v95
    s_setprio 1
    v_exp_f32 v64, v64
    v_exp_f32 v65, v65
    s_waitcnt lgkmcnt(3)
    v_mfma_f32_32x32x16_bf16 v[96:111], v[28:31], v[124:127], v[96:111]
    ds_read_b128 v[28:31], v1 offset:11264
    buffer_load_dwordx4 v[232:235], v39, s[32:35], s28 offen offset:2048 sc1
    v_exp_f32 v66, v66
    v_exp_f32 v67, v67
    v_exp_f32 v68, v68
    v_exp_f32 v69, v69
    s_waitcnt lgkmcnt(3)
    v_mfma_f32_32x32x16_bf16 v[80:95], v[16:19], v[8:11], v[48:63]
    ds_read_b128 v[16:19], v2 offset:0
    v_exp_f32 v70, v70
    v_exp_f32 v71, v71
    v_cvt_pk_bf16_f32 v120, v64, v65
    v_cvt_pk_bf16_f32 v121, v66, v67
    v_mfma_f32_16x16x32_bf16 v[112:115], v[40:43], v[124:127], v[112:115]
    v_cvt_pk_bf16_f32 v122, v68, v69
    v_cvt_pk_bf16_f32 v123, v70, v71
    v_exp_f32 v72, v72
    s_waitcnt lgkmcnt(3)
    v_mfma_f32_32x32x16_bf16 v[80:95], v[20:23], v[12:15], v[80:95]
    ds_read_b128 v[20:23], v2 offset:1024
    v_exp_f32 v73, v73
    v_exp_f32 v74, v74
    v_exp_f32 v75, v75
    s_waitcnt lgkmcnt(3)
    v_mfma_f32_32x32x16_bf16 v[96:111], v[24:27], v[120:123], v[96:111]
    ds_read_b128 v[24:27], v1 offset:14336
    v_exp_f32 v76, v76
    v_exp_f32 v77, v77
    v_exp_f32 v78, v78
    v_mfma_f32_16x16x32_bf16 v[112:115], v[40:43], v[120:123], v[112:115]
    v_exp_f32 v79, v79
    v_cvt_pk_bf16_f32 v124, v72, v73
    v_cvt_pk_bf16_f32 v125, v74, v75
    v_cvt_pk_bf16_f32 v126, v76, v77
    v_cvt_pk_bf16_f32 v127, v78, v79
    s_setprio 0
    v_exp_f32 v80, v80
    v_exp_f32 v81, v81
    s_waitcnt lgkmcnt(3)
    v_mfma_f32_32x32x16_bf16 v[96:111], v[28:31], v[124:127], v[96:111]
    ds_read_b128 v[28:31], v1 offset:15360
    buffer_load_dwordx4 v[236:239], v39, s[32:35], s28 offen offset:2304 sc1
    s_add_u32 s28, s28, 4096
    v_exp_f32 v82, v82
    v_exp_f32 v83, v83
    v_exp_f32 v84, v84
    v_exp_f32 v85, v85
    s_waitcnt lgkmcnt(3)
    v_mfma_f32_32x32x16_bf16 v[64:79], v[16:19], v[8:11], v[48:63]
    ds_read_b128 v[16:19], v2 offset:4096
    v_exp_f32 v86, v86
    v_exp_f32 v87, v87
    v_cvt_pk_bf16_f32 v120, v80, v81
    v_cvt_pk_bf16_f32 v121, v82, v83
    v_mfma_f32_16x16x32_bf16 v[112:115], v[40:43], v[124:127], v[112:115]
    v_cvt_pk_bf16_f32 v122, v84, v85
    v_cvt_pk_bf16_f32 v123, v86, v87
    v_exp_f32 v88, v88
    s_waitcnt lgkmcnt(3)
    v_mfma_f32_32x32x16_bf16 v[64:79], v[20:23], v[12:15], v[64:79]
    ds_read_b128 v[20:23], v2 offset:5120
    v_exp_f32 v89, v89
    v_exp_f32 v90, v90
    v_exp_f32 v91, v91
    s_waitcnt lgkmcnt(3)
    v_mfma_f32_32x32x16_bf16 v[96:111], v[24:27], v[120:123], v[96:111]
    ds_read_b128 v[24:27], v2 offset:2048
    v_exp_f32 v92, v92
    v_exp_f32 v93, v93
    v_exp_f32 v94, v94
    v_mfma_f32_16x16x32_bf16 v[112:115], v[40:43], v[120:123], v[112:115]
    v_exp_f32 v95, v95
    v_cvt_pk_bf16_f32 v124, v88, v89
    v_cvt_pk_bf16_f32 v125, v90, v91
    v_cvt_pk_bf16_f32 v126, v92, v93
    v_cvt_pk_bf16_f32 v127, v94, v95
    v_mov_b32 v1, v2
    v_add_u32 v2, 16384, v2
    v_and_b32 v2, 65535, v2
    s_setprio 3
    v_exp_f32 v64, v64
    v_exp_f32 v65, v65
    s_waitcnt lgkmcnt(3)
    v_mfma_f32_32x32x16_bf16 v[96:111], v[28:31], v[124:127], v[96:111]
    ds_read_b128 v[28:31], v1 offset:3072
    buffer_load_dwordx4 v[240:243], v39, s[32:35], s28 offen offset:0 sc1
    v_exp_f32 v66, v66
    v_exp_f32 v67, v67
    v_exp_f32 v68, v68
    v_exp_f32 v69, v69
    s_waitcnt lgkmcnt(3)
    v_mfma_f32_32x32x16_bf16 v[80:95], v[16:19], v[8:11], v[48:63]
    ds_read_b128 v[16:19], v1 offset:8192
    v_exp_f32 v70, v70
    v_exp_f32 v71, v71
    v_cvt_pk_bf16_f32 v120, v64, v65
    v_cvt_pk_bf16_f32 v121, v66, v67
    v_mfma_f32_16x16x32_bf16 v[112:115], v[40:43], v[124:127], v[112:115]
    v_cvt_pk_bf16_f32 v122, v68, v69
    v_cvt_pk_bf16_f32 v123, v70, v71
    v_exp_f32 v72, v72
    s_waitcnt lgkmcnt(3)
    v_mfma_f32_32x32x16_bf16 v[80:95], v[20:23], v[12:15], v[80:95]
    ds_read_b128 v[20:23], v1 offset:9216
    buffer_load_dwordx4 v[244:247], v39, s[32:35], s28 offen offset:256 sc1
    v_exp_f32 v73, v73
    v_exp_f32 v74, v74
    v_exp_f32 v75, v75
    s_waitcnt lgkmcnt(3)
    v_mfma_f32_32x32x16_bf16 v[96:111], v[24:27], v[120:123], v[96:111]
    ds_read_b128 v[24:27], v1 offset:6144
    v_exp_f32 v76, v76
    v_exp_f32 v77, v77
    v_exp_f32 v78, v78
    v_mfma_f32_16x16x32_bf16 v[112:115], v[40:43], v[120:123], v[112:115]
    v_exp_f32 v79, v79
    v_cvt_pk_bf16_f32 v124, v72, v73
    v_cvt_pk_bf16_f32 v125, v74, v75
    v_cvt_pk_bf16_f32 v126, v76, v77
    v_cvt_pk_bf16_f32 v127, v78, v79
    s_setprio 2
    v_exp_f32 v80, v80
    v_exp_f32 v81, v81
    s_waitcnt lgkmcnt(3)
    v_mfma_f32_32x32x16_bf16 v[96:111], v[28:31], v[124:127], v[96:111]
    ds_read_b128 v[28:31], v1 offset:7168
    buffer_load_dwordx4 v[248:251], v39, s[32:35], s28 offen offset:2048 sc1
    v_exp_f32 v82, v82
    v_exp_f32 v83, v83
    v_exp_f32 v84, v84
    v_exp_f32 v85, v85
    s_waitcnt lgkmcnt(3)
    v_mfma_f32_32x32x16_bf16 v[64:79], v[16:19], v[8:11], v[48:63]
    ds_read_b128 v[16:19], v1 offset:12288
    v_exp_f32 v86, v86
    v_exp_f32 v87, v87
    v_cvt_pk_bf16_f32 v120, v80, v81
    v_cvt_pk_bf16_f32 v121, v82, v83
    v_mfma_f32_16x16x32_bf16 v[112:115], v[40:43], v[124:127], v[112:115]
    v_cvt_pk_bf16_f32 v122, v84, v85
    v_cvt_pk_bf16_f32 v123, v86, v87
    v_exp_f32 v88, v88
    s_waitcnt lgkmcnt(3)
    v_mfma_f32_32x32x16_bf16 v[64:79], v[20:23], v[12:15], v[64:79]
    ds_read_b128 v[20:23], v1 offset:13312
    buffer_load_dwordx4 v[252:255], v39, s[32:35], s28 offen offset:2304 sc1
    s_add_u32 s28, s28, 4096
    v_exp_f32 v89, v89
    v_exp_f32 v90, v90
    v_exp_f32 v91, v91
    s_waitcnt lgkmcnt(3)
    v_mfma_f32_32x32x16_bf16 v[96:111], v[24:27], v[120:123], v[96:111]
    ds_read_b128 v[24:27], v1 offset:10240
    v_exp_f32 v92, v92
    v_exp_f32 v93, v93
    v_exp_f32 v94, v94
    v_mfma_f32_16x16x32_bf16 v[112:115], v[40:43], v[120:123], v[112:115]
    v_exp_f32 v95, v95
    v_cvt_pk_bf16_f32 v124, v88, v89
    v_cvt_pk_bf16_f32 v125, v90, v91
    v_cvt_pk_bf16_f32 v126, v92, v93
    v_cvt_pk_bf16_f32 v127, v94, v95
    s_setprio 1
    v_exp_f32 v64, v64
    v_exp_f32 v65, v65
    s_waitcnt lgkmcnt(3)
    v_mfma_f32_32x32x16_bf16 v[96:111], v[28:31], v[124:127], v[96:111]
    ds_read_b128 v[28:31], v1 offset:11264
    v_exp_f32 v66, v66
    v_exp_f32 v67, v67
    v_exp_f32 v68, v68
    v_exp_f32 v69, v69
    s_waitcnt lgkmcnt(3)
    v_mfma_f32_32x32x16_bf16 v[80:95], v[16:19], v[8:11], v[48:63]
    ds_read_b128 v[16:19], v2 offset:0
    v_exp_f32 v70, v70
    v_exp_f32 v71, v71
    v_cvt_pk_bf16_f32 v120, v64, v65
    v_cvt_pk_bf16_f32 v121, v66, v67
    v_mfma_f32_16x16x32_bf16 v[112:115], v[40:43], v[124:127], v[112:115]
    v_cvt_pk_bf16_f32 v122, v68, v69
    v_cvt_pk_bf16_f32 v123, v70, v71
    v_exp_f32 v72, v72
    s_waitcnt lgkmcnt(3)
    v_mfma_f32_32x32x16_bf16 v[80:95], v[20:23], v[12:15], v[80:95]
    ds_read_b128 v[20:23], v2 offset:1024
    v_exp_f32 v73, v73
    v_exp_f32 v74, v74
    v_exp_f32 v75, v75
    s_waitcnt lgkmcnt(3)
    v_mfma_f32_32x32x16_bf16 v[96:111], v[24:27], v[120:123], v[96:111]
    ds_read_b128 v[24:27], v1 offset:14336
    v_exp_f32 v76, v76
    v_exp_f32 v77, v77
    v_exp_f32 v78, v78
    v_mfma_f32_16x16x32_bf16 v[112:115], v[40:43], v[120:123], v[112:115]
    v_exp_f32 v79, v79
    v_cvt_pk_bf16_f32 v124, v72, v73
    v_cvt_pk_bf16_f32 v125, v74, v75
    v_cvt_pk_bf16_f32 v126, v76, v77
    v_cvt_pk_bf16_f32 v127, v78, v79
    s_setprio 0
    v_exp_f32 v80, v80
    v_exp_f32 v81, v81
    s_waitcnt lgkmcnt(3)
    v_mfma_f32_32x32x16_bf16 v[96:111], v[28:31], v[124:127], v[96:111]
    ds_read_b128 v[28:31], v1 offset:15360
    v_exp_f32 v82, v82
    v_exp_f32 v83, v83
    v_exp_f32 v84, v84
    v_exp_f32 v85, v85
    s_waitcnt lgkmcnt(3)
    v_mfma_f32_32x32x16_bf16 v[64:79], v[16:19], v[8:11], v[48:63]
    ds_read_b128 v[16:19], v2 offset:4096
    v_exp_f32 v86, v86
    v_exp_f32 v87, v87
    v_cvt_pk_bf16_f32 v120, v80, v81
    v_cvt_pk_bf16_f32 v121, v82, v83
    v_mfma_f32_16x16x32_bf16 v[112:115], v[40:43], v[124:127], v[112:115]
    v_cvt_pk_bf16_f32 v122, v84, v85
    v_cvt_pk_bf16_f32 v123, v86, v87
    v_exp_f32 v88, v88
    s_waitcnt lgkmcnt(3)
    v_mfma_f32_32x32x16_bf16 v[64:79], v[20:23], v[12:15], v[64:79]
    ds_read_b128 v[20:23], v2 offset:5120
    v_exp_f32 v89, v89
    v_exp_f32 v90, v90
    v_exp_f32 v91, v91
    s_waitcnt lgkmcnt(3)
    v_mfma_f32_32x32x16_bf16 v[96:111], v[24:27], v[120:123], v[96:111]
    ds_read_b128 v[24:27], v2 offset:2048
    v_exp_f32 v92, v92
    v_exp_f32 v93, v93
    v_exp_f32 v94, v94
    v_mfma_f32_16x16x32_bf16 v[112:115], v[40:43], v[120:123], v[112:115]
    v_exp_f32 v95, v95
    v_cvt_pk_bf16_f32 v124, v88, v89
    v_cvt_pk_bf16_f32 v125, v90, v91
    v_cvt_pk_bf16_f32 v126, v92, v93
    v_cvt_pk_bf16_f32 v127, v94, v95
    v_mov_b32 v1, v2
    v_add_u32 v2, 16384, v2
    v_and_b32 v2, 65535, v2
    s_mov_b32 s60, 16
    s_waitcnt lgkmcnt(0)
    v_mfma_f32_32x32x16_bf16 v[96:111], v[28:31], v[124:127], v[96:111]
    v_mfma_f32_16x16x32_bf16 v[112:115], v[40:43], v[124:127], v[112:115]
    v_lshlrev_b32 v45, 3, v0
    s_nop 11
K2_FIN:
    v_rcp_f32 v4, v112
    s_nop 0
    v_pk_mul_f32 v[96:97], v[96:97], v[4:5] op_sel_hi:[1,0]
    v_pk_mul_f32 v[98:99], v[98:99], v[4:5] op_sel_hi:[1,0]
    v_pk_mul_f32 v[100:101], v[100:101], v[4:5] op_sel_hi:[1,0]
    v_pk_mul_f32 v[102:103], v[102:103], v[4:5] op_sel_hi:[1,0]
    v_pk_mul_f32 v[104:105], v[104:105], v[4:5] op_sel_hi:[1,0]
    v_pk_mul_f32 v[106:107], v[106:107], v[4:5] op_sel_hi:[1,0]
    v_pk_mul_f32 v[108:109], v[108:109], v[4:5] op_sel_hi:[1,0]
    v_pk_mul_f32 v[110:111], v[110:111], v[4:5] op_sel_hi:[1,0]
    v_cvt_pk_bf16_f32 v120, v96, v97
    v_cvt_pk_bf16_f32 v121, v98, v99
    v_cvt_pk_bf16_f32 v122, v100, v101
    v_cvt_pk_bf16_f32 v123, v102, v103
    v_cvt_pk_bf16_f32 v124, v104, v105
    v_cvt_pk_bf16_f32 v125, v106, v107
    v_cvt_pk_bf16_f32 v126, v108, v109
    v_cvt_pk_bf16_f32 v127, v110, v111
    buffer_store_dwordx4 v[120:123], v3, s[32:35], s73 offen sc1
    buffer_store_dwordx4 v[124:127], v3, s[32:35], s73 offen offset:1024 sc1
    v_mov_b32 v6, 0
    v_fma_f32 v6, v96, 0, v6
    v_fma_f32 v6, v97, 0, v6
    v_fma_f32 v6, v98, 0, v6
    v_fma_f32 v6, v99, 0, v6
    v_fma_f32 v6, v100, 0, v6
    v_fma_f32 v6, v101, 0, v6
    v_fma_f32 v6, v102, 0, v6
    v_fma_f32 v6, v103, 0, v6
    v_fma_f32 v6, v104, 0, v6
    v_fma_f32 v6, v105, 0, v6
    v_fma_f32 v6, v106, 0, v6
    v_fma_f32 v6, v107, 0, v6
    v_fma_f32 v6, v108, 0, v6
    v_fma_f32 v6, v109, 0, v6
    v_fma_f32 v6, v110, 0, v6
    v_fma_f32 v6, v111, 0, v6
    v_mov_b32 v7, 0x7b800000
    v_cmp_u_f32 vcc, v6, v6
    v_cmp_nlt_f32 s[62:63], v112, v7
    s_or_b64 vcc, vcc, s[62:63]
    s_cmp_eq_u32 s60, 16
    s_cselect_b64 vcc, vcc, 0
    s_cbranch_vccnz K2_FB
    s_cmp_lt_u32 s40, 4
    s_cbranch_scc0 K3_EF1
    s_waitcnt vmcnt(2)
    s_barrier
    s_waitcnt vmcnt(0)
    s_mov_b64 exec, 1
    v_mov_b32 v4, 1
    v_mov_b32 v5, 0
    buffer_store_dword v4, v5, s[32:35], s69 offen sc1
    s_mov_b64 exec, -1
    s_branch K3_EF2
K3_EF1:
    s_setprio 1
    s_waitcnt vmcnt(2)
    s_barrier
K3_EF2:
    s_mov_b32 s20, s6
    s_mov_b32 s21, s7
    s_mov_b32 s29, 0
    v_add_u32 v40, 65536, v38
    v_xor_b32 v41, 32, v40
    v_xor_b32 v42, 64, v40
    v_xor_b32 v43, 0x60, v40
    s_nop 0
    ds_read_b64_tr_b16 v[16:17], v40 offset:0
    ds_read_b64_tr_b16 v[18:19], v40 offset:1024
    ds_read_b64_tr_b16 v[20:21], v41 offset:0
    ds_read_b64_tr_b16 v[22:23], v41 offset:1024
    ds_read_b64_tr_b16 v[24:25], v42 offset:0
    ds_read_b64_tr_b16 v[26:27], v42 offset:1024
    ds_read_b64_tr_b16 v[28:29], v43 offset:0
    ds_read_b64_tr_b16 v[30:31], v43 offset:1024
    ds_read_b64_tr_b16 v[48:49], v40 offset:4096
    ds_read_b64_tr_b16 v[50:51], v40 offset:5120
    ds_read_b64_tr_b16 v[52:53], v41 offset:4096
    ds_read_b64_tr_b16 v[54:55], v41 offset:5120
    ds_read_b64_tr_b16 v[56:57], v42 offset:4096
    ds_read_b64_tr_b16 v[58:59], v42 offset:5120
    ds_read_b64_tr_b16 v[60:61], v43 offset:4096
    ds_read_b64_tr_b16 v[62:63], v43 offset:5120
    s_waitcnt lgkmcnt(14)
    v_mfma_f32_16x16x32_bf16 v[64:67], v[16:19], v[128:131], 0
    s_waitcnt lgkmcnt(12)
    v_mfma_f32_16x16x32_bf16 v[72:75], v[20:23], v[128:131], 0
    s_waitcnt lgkmcnt(10)
    v_mfma_f32_16x16x32_bf16 v[80:83], v[24:27], v[128:131], 0
    s_waitcnt lgkmcnt(8)
    v_mfma_f32_16x16x32_bf16 v[88:91], v[28:31], v[128:131], 0
    v_add_u32 v40, 81920, v38
    v_xor_b32 v41, 32, v40
    v_xor_b32 v42, 64, v40
    v_xor_b32 v43, 0x60, v40
    s_add_u32 m0, s30, 32768
    s_nop 0
    buffer_load_dwordx4 v36, s[20:23], s29 offen lds
    v_mfma_f32_16x16x32_bf16 v[68:71], v[16:19], v[132:135], 0
    ds_read_b64_tr_b16 v[16:17], v40 offset:0
    ds_read_b64_tr_b16 v[18:19], v40 offset:1024
    v_mfma_f32_16x16x32_bf16 v[76:79], v[20:23], v[132:135], 0
    ds_read_b64_tr_b16 v[20:21], v41 offset:0
    ds_read_b64_tr_b16 v[22:23], v41 offset:1024
    v_mfma_f32_16x16x32_bf16 v[84:87], v[24:27], v[132:135], 0
    ds_read_b64_tr_b16 v[24:25], v42 offset:0
    ds_read_b64_tr_b16 v[26:27], v42 offset:1024
    v_mfma_f32_16x16x32_bf16 v[92:95], v[28:31], v[132:135], 0
    ds_read_b64_tr_b16 v[28:29], v43 offset:0
    ds_read_b64_tr_b16 v[30:31], v43 offset:1024
    buffer_load_dwordx4 v37, s[20:23], s29 offen offset:1024 lds
    s_add_u32 s29, s29, 131072
    s_waitcnt lgkmcnt(14)
    v_mfma_f32_16x16x32_bf16 v[64:67], v[48:51], v[136:139], v[64:67]
    s_waitcnt lgkmcnt(12)
    v_mfma_f32_16x16x32_bf16 v[72:75], v[52:55], v[136:139], v[72:75]
    s_waitcnt lgkmcnt(10)
    v_mfma_f32_16x16x32_bf16 v[80:83], v[56:59], v[136:139], v[80:83]
    s_waitcnt lgkmcnt(8)
    v_mfma_f32_16x16x32_bf16 v[88:91], v[60:63], v[136:139], v[88:91]
    v_mfma_f32_16x16x32_bf16 v[68:71], v[48:51], v[140:143], v[68:71]
    ds_read_b64_tr_b16 v[48:49], v40 offset:4096
    ds_read_b64_tr_b16 v[50:51], v40 offset:5120
    v_mfma_f32_16x16x32_bf16 v[76:79], v[52:55], v[140:143], v[76:79]
    ds_read_b64_tr_b16 v[52:53], v41 offset:4096
    ds_read_b64_tr_b16 v[54:55], v41 offset:5120
    v_mfma_f32_16x16x32_bf16 v[84:87], v[56:59], v[140:143], v[84:87]
    ds_read_b64_tr_b16 v[56:57], v42 offset:4096
    ds_read_b64_tr_b16 v[58:59], v42 offset:5120
    v_mfma_f32_16x16x32_bf16 v[92:95], v[60:63], v[140:143], v[92:95]
    ds_read_b64_tr_b16 v[60:61], v43 offset:4096
    ds_read_b64_tr_b16 v[62:63], v43 offset:5120
    s_cmp_lt_u32 s40, 4
    s_cbranch_scc1 K3_F_21
    s_waitcnt vmcnt(2)
    s_mov_b64 exec, 1
    v_mov_b32 v4, 1
    v_mov_b32 v5, 0
    buffer_store_dword v4, v5, s[32:35], s69 offen sc1
    s_mov_b64 exec, -1
    s_setprio 0
K3_F_21:
    s_waitcnt lgkmcnt(14)
    v_mfma_f32_16x16x32_bf16 v[64:67], v[16:19], v[144:147], v[64:67]
    s_waitcnt lgkmcnt(12)
    v_mfma_f32_16x16x32_bf16 v[72:75], v[20:23], v[144:147], v[72:75]
    s_waitcnt lgkmcnt(10)
    v_mfma_f32_16x16x32_bf16 v[80:83], v[24:27], v[144:147], v[80:83]
    s_waitcnt lgkmcnt(8)
    v_mfma_f32_16x16x32_bf16 v[88:91], v[28:31], v[144:147], v[88:91]
    v_add_u32 v40, 98304, v38
    v_xor_b32 v41, 32, v40
    v_xor_b32 v42, 64, v40
    v_xor_b32 v43, 0x60, v40
    s_add_u32 m0, s30, 49152
    s_nop 0
    buffer_load_dwordx4 v36, s[20:23], s29 offen lds
    v_mfma_f32_16x16x32_bf16 v[68:71], v[16:19], v[148:151], v[68:71]
    ds_read_b64_tr_b16 v[16:17], v40 offset:0
    ds_read_b64_tr_b16 v[18:19], v40 offset:1024
    v_mfma_f32_16x16x32_bf16 v[76:79], v[20:23], v[148:151], v[76:79]
    ds_read_b64_tr_b16 v[20:21], v41 offset:0
    ds_read_b64_tr_b16 v[22:23], v41 offset:1024
    v_mfma_f32_16x16x32_bf16 v[84:87], v[24:27], v[148:151], v[84:87]
    ds_read_b64_tr_b16 v[24:25], v42 offset:0
    ds_read_b64_tr_b16 v[26:27], v42 offset:1024
    v_mfma_f32_16x16x32_bf16 v[92:95], v[28:31], v[148:151], v[92:95]
    ds_read_b64_tr_b16 v[28:29], v43 offset:0
    ds_read_b64_tr_b16 v[30:31], v43 offset:1024
    buffer_load_dwordx4 v37, s[20:23], s29 offen offset:1024 lds
    s_add_u32 s29, s29, 131072
    s_waitcnt lgkmcnt(14)
    v_mfma_f32_16x16x32_bf16 v[64:67], v[48:51], v[152:155], v[64:67]
    s_waitcnt lgkmcnt(12)
    v_mfma_f32_16x16x32_bf16 v[72:75], v[52:55], v[152:155], v[72:75]
    s_waitcnt lgkmcnt(10)
    v_mfma_f32_16x16x32_bf16 v[80:83], v[56:59], v[152:155], v[80:83]
    s_waitcnt lgkmcnt(8)
    v_mfma_f32_16x16x32_bf16 v[88:91], v[60:63], v[152:155], v[88:91]
    v_mfma_f32_16x16x32_bf16 v[68:71], v[48:51], v[156:159], v[68:71]
    ds_read_b64_tr_b16 v[48:49], v40 offset:4096
    ds_read_b64_tr_b16 v[50:51], v40 offset:5120
    v_mfma_f32_16x16x32_bf16 v[76:79], v[52:55], v[156:159], v[76:79]
    ds_read_b64_tr_b16 v[52:53], v41 offset:4096
    ds_read_b64_tr_b16 v[54:55], v41 offset:5120
    v_mfma_f32_16x16x32_bf16 v[84:87], v[56:59], v[156:159], v[84:87]
    ds_read_b64_tr_b16 v[56:57], v42 offset:4096
    ds_read_b64_tr_b16 v[58:59], v42 offset:5120
    v_mfma_f32_16x16x32_bf16 v[92:95], v[60:63], v[156:159], v[92:95]
    ds_read_b64_tr_b16 v[60:61], v43 offset:4096
    ds_read_b64_tr_b16 v[62:63], v43 offset:5120
    s_waitcnt lgkmcnt(14)
    v_mfma_f32_16x16x32_bf16 v[64:67], v[16:19], v[160:163], v[64:67]
    s_waitcnt lgkmcnt(12)
    v_mfma_f32_16x16x32_bf16 v[72:75], v[20:23], v[160:163], v[72:75]
    s_waitcnt lgkmcnt(10)
    v_mfma_f32_16x16x32_bf16 v[80:83], v[24:27], v[160:163], v[80:83]
    s_waitcnt lgkmcnt(8)
    v_mfma_f32_16x16x32_bf16 v[88:91], v[28:31], v[160:163], v[88:91]
    v_add_u32 v40, 114688, v38
    v_xor_b32 v41, 32, v40
    v_xor_b32 v42, 64, v40
    v_xor_b32 v43, 0x60, v40
    v_mfma_f32_16x16x32_bf16 v[68:71], v[16:19], v[164:167], v[68:71]
    ds_read_b64_tr_b16 v[16:17], v40 offset:0
    ds_read_b64_tr_b16 v[18:19], v40 offset:1024
    v_mfma_f32_16x16x32_bf16 v[76:79], v[20:23], v[164:167], v[76:79]
    ds_read_b64_tr_b16 v[20:21], v41 offset:0
    ds_read_b64_tr_b16 v[22:23], v41 offset:1024
    v_mfma_f32_16x16x32_bf16 v[84:87], v[24:27], v[164:167], v[84:87]
    ds_read_b64_tr_b16 v[24:25], v42 offset:0
    ds_read_b64_tr_b16 v[26:27], v42 offset:1024
    v_mfma_f32_16x16x32_bf16 v[92:95], v[28:31], v[164:167], v[92:95]
    ds_read_b64_tr_b16 v[28:29], v43 offset:0
    ds_read_b64_tr_b16 v[30:31], v43 offset:1024
    s_waitcnt lgkmcnt(14)
    v_mfma_f32_16x16x32_bf16 v[64:67], v[48:51], v[168:171], v[64:67]
    s_waitcnt lgkmcnt(12)
    v_mfma_f32_16x16x32_bf16 v[72:75], v[52:55], v[168:171], v[72:75]
    s_waitcnt lgkmcnt(10)
    v_mfma_f32_16x16x32_bf16 v[80:83], v[56:59], v[168:171], v[80:83]
    s_waitcnt lgkmcnt(8)
    v_mfma_f32_16x16x32_bf16 v[88:91], v[60:63], v[168:171], v[88:91]
    v_mfma_f32_16x16x32_bf16 v[68:71], v[48:51], v[172:175], v[68:71]
    ds_read_b64_tr_b16 v[48:49], v40 offset:4096
    ds_read_b64_tr_b16 v[50:51], v40 offset:5120
    v_mfma_f32_16x16x32_bf16 v[76:79], v[52:55], v[172:175], v[76:79]
    ds_read_b64_tr_b16 v[52:53], v41 offset:4096
    ds_read_b64_tr_b16 v[54:55], v41 offset:5120
    v_mfma_f32_16x16x32_bf16 v[84:87], v[56:59], v[172:175], v[84:87]
    ds_read_b64_tr_b16 v[56:57], v42 offset:4096
    ds_read_b64_tr_b16 v[58:59], v42 offset:5120
    v_mfma_f32_16x16x32_bf16 v[92:95], v[60:63], v[172:175], v[92:95]
    ds_read_b64_tr_b16 v[60:61], v43 offset:4096
    ds_read_b64_tr_b16 v[62:63], v43 offset:5120
    s_waitcnt lgkmcnt(14)
    v_mfma_f32_16x16x32_bf16 v[64:67], v[16:19], v[176:179], v[64:67]
    s_waitcnt lgkmcnt(12)
    v_mfma_f32_16x16x32_bf16 v[72:75], v[20:23], v[176:179], v[72:75]
    s_waitcnt lgkmcnt(10)
    v_mfma_f32_16x16x32_bf16 v[80:83], v[24:27], v[176:179], v[80:83]
    s_waitcnt lgkmcnt(8)
    v_mfma_f32_16x16x32_bf16 v[88:91], v[28:31], v[176:179], v[88:91]
    v_add_u32 v40, 131072, v38
    v_xor_b32 v41, 32, v40
    v_xor_b32 v42, 64, v40
    v_xor_b32 v43, 0x60, v40
    v_mfma_f32_16x16x32_bf16 v[68:71], v[16:19], v[180:183], v[68:71]
    ds_read_b64_tr_b16 v[16:17], v40 offset:0
    ds_read_b64_tr_b16 v[18:19], v40 offset:1024
    v_mfma_f32_16x16x32_bf16 v[76:79], v[20:23], v[180:183], v[76:79]
    ds_read_b64_tr_b16 v[20:21], v41 offset:0
    ds_read_b64_tr_b16 v[22:23], v41 offset:1024
    v_mfma_f32_16x16x32_bf16 v[84:87], v[24:27], v[180:183], v[84:87]
    ds_read_b64_tr_b16 v[24:25], v42 offset:0
    ds_read_b64_tr_b16 v[26:27], v42 offset:1024
    v_mfma_f32_16x16x32_bf16 v[92:95], v[28:31], v[180:183], v[92:95]
    ds_read_b64_tr_b16 v[28:29], v43 offset:0
    ds_read_b64_tr_b16 v[30:31], v43 offset:1024
    s_waitcnt lgkmcnt(14)
    v_mfma_f32_16x16x32_bf16 v[64:67], v[48:51], v[184:187], v[64:67]
    s_waitcnt lgkmcnt(12)
    v_mfma_f32_16x16x32_bf16 v[72:75], v[52:55], v[184:187], v[72:75]
    s_waitcnt lgkmcnt(10)
    v_mfma_f32_16x16x32_bf16 v[80:83], v[56:59], v[184:187], v[80:83]
    s_waitcnt lgkmcnt(8)
    v_mfma_f32_16x16x32_bf16 v[88:91], v[60:63], v[184:187], v[88:91]
    v_mfma_f32_16x16x32_bf16 v[68:71], v[48:51], v[188:191], v[68:71]
    ds_read_b64_tr_b16 v[48:49], v40 offset:4096
    ds_read_b64_tr_b16 v[50:51], v40 offset:5120
    v_mfma_f32_16x16x32_bf16 v[76:79], v[52:55], v[188:191], v[76:79]
    ds_read_b64_tr_b16 v[52:53], v41 offset:4096
    ds_read_b64_tr_b16 v[54:55], v41 offset:5120
    v_mfma_f32_16x16x32_bf16 v[84:87], v[56:59], v[188:191], v[84:87]
    ds_read_b64_tr_b16 v[56:57], v42 offset:4096
    ds_read_b64_tr_b16 v[58:59], v42 offset:5120
    v_mfma_f32_16x16x32_bf16 v[92:95], v[60:63], v[188:191], v[92:95]
    ds_read_b64_tr_b16 v[60:61], v43 offset:4096
    ds_read_b64_tr_b16 v[62:63], v43 offset:5120
    s_barrier
    s_waitcnt lgkmcnt(14)
    v_mfma_f32_16x16x32_bf16 v[64:67], v[16:19], v[192:195], v[64:67]
    s_waitcnt lgkmcnt(12)
    v_mfma_f32_16x16x32_bf16 v[72:75], v[20:23], v[192:195], v[72:75]
    s_waitcnt lgkmcnt(10)
    v_mfma_f32_16x16x32_bf16 v[80:83], v[24:27], v[192:195], v[80:83]
    s_waitcnt lgkmcnt(8)
    v_mfma_f32_16x16x32_bf16 v[88:91], v[28:31], v[192:195], v[88:91]
    v_add_u32 v40, 147456, v38
    v_xor_b32 v41, 32, v40
    v_xor_b32 v42, 64, v40
    v_xor_b32 v43, 0x60, v40
    s_add_u32 m0, s30, 65536
    s_nop 0
    buffer_load_dwordx4 v36, s[20:23], s29 offen lds
    v_mfma_f32_16x16x32_bf16 v[68:71], v[16:19], v[196:199], v[68:71]
    ds_read_b64_tr_b16 v[16:17], v40 offset:0
    ds_read_b64_tr_b16 v[18:19], v40 offset:1024
    v_mfma_f32_16x16x32_bf16 v[76:79], v[20:23], v[196:199], v[76:79]
    ds_read_b64_tr_b16 v[20:21], v41 offset:0
    ds_read_b64_tr_b16 v[22:23], v41 offset:1024
    v_mfma_f32_16x16x32_bf16 v[84:87], v[24:27], v[196:199], v[84:87]
    ds_read_b64_tr_b16 v[24:25], v42 offset:0
    ds_read_b64_tr_b16 v[26:27], v42 offset:1024
    v_mfma_f32_16x16x32_bf16 v[92:95], v[28:31], v[196:199], v[92:95]
    ds_read_b64_tr_b16 v[28:29], v43 offset:0
    ds_read_b64_tr_b16 v[30:31], v43 offset:1024
    buffer_load_dwordx4 v37, s[20:23], s29 offen offset:1024 lds
    s_add_u32 s29, s29, 131072
    s_waitcnt lgkmcnt(14)
    v_mfma_f32_16x16x32_bf16 v[64:67], v[48:51], v[200:203], v[64:67]
    s_waitcnt lgkmcnt(12)
    v_mfma_f32_16x16x32_bf16 v[72:75], v[52:55], v[200:203], v[72:75]
    s_waitcnt lgkmcnt(10)
    v_mfma_f32_16x16x32_bf16 v[80:83], v[56:59], v[200:203], v[80:83]
    s_waitcnt lgkmcnt(8)
    v_mfma_f32_16x16x32_bf16 v[88:91], v[60:63], v[200:203], v[88:91]
    s_add_u32 m0, s30, 81920
    s_nop 0
    buffer_load_dwordx4 v36, s[20:23], s29 offen lds
    v_mfma_f32_16x16x32_bf16 v[68:71], v[48:51], v[204:207], v[68:71]
    ds_read_b64_tr_b16 v[48:49], v40 offset:4096
    ds_read_b64_tr_b16 v[50:51], v40 offset:5120
    v_mfma_f32_16x16x32_bf16 v[76:79], v[52:55], v[204:207], v[76:79]
    ds_read_b64_tr_b16 v[52:53], v41 offset:4096
    ds_read_b64_tr_b16 v[54:55], v41 offset:5120
    v_mfma_f32_16x16x32_bf16 v[84:87], v[56:59], v[204:207], v[84:87]
    ds_read_b64_tr_b16 v[56:57], v42 offset:4096
    ds_read_b64_tr_b16 v[58:59], v42 offset:5120
    v_mfma_f32_16x16x32_bf16 v[92:95], v[60:63], v[204:207], v[92:95]
    ds_read_b64_tr_b16 v[60:61], v43 offset:4096
    ds_read_b64_tr_b16 v[62:63], v43 offset:5120
    buffer_load_dwordx4 v37, s[20:23], s29 offen offset:1024 lds
    s_add_u32 s29, s29, 131072
    s_waitcnt lgkmcnt(14)
    v_mfma_f32_16x16x32_bf16 v[64:67], v[16:19], v[208:211], v[64:67]
    s_waitcnt lgkmcnt(12)
    v_mfma_f32_16x16x32_bf16 v[72:75], v[20:23], v[208:211], v[72:75]
    s_waitcnt lgkmcnt(10)
    v_mfma_f32_16x16x32_bf16 v[80:83], v[24:27], v[208:211], v[80:83]
    s_waitcnt lgkmcnt(8)
    v_mfma_f32_16x16x32_bf16 v[88:91], v[28:31], v[208:211], v[88:91]
    v_add_u32 v40, 0, v38
    v_xor_b32 v41, 32, v40
    v_xor_b32 v42, 64, v40
    v_xor_b32 v43, 0x60, v40
    s_add_u32 m0, s30, 98304
    s_nop 0
    buffer_load_dwordx4 v36, s[20:23], s29 offen lds
    v_mfma_f32_16x16x32_bf16 v[68:71], v[16:19], v[212:215], v[68:71]
    ds_read_b64_tr_b16 v[16:17], v40 offset:0
    ds_read_b64_tr_b16 v[18:19], v40 offset:1024
    v_mfma_f32_16x16x32_bf16 v[76:79], v[20:23], v[212:215], v[76:79]
    ds_read_b64_tr_b16 v[20:21], v41 offset:0
    ds_read_b64_tr_b16 v[22:23], v41 offset:1024
    v_mfma_f32_16x16x32_bf16 v[84:87], v[24:27], v[212:215], v[84:87]
    ds_read_b64_tr_b16 v[24:25], v42 offset:0
    ds_read_b64_tr_b16 v[26:27], v42 offset:1024
    v_mfma_f32_16x16x32_bf16 v[92:95], v[28:31], v[212:215], v[92:95]
    ds_read_b64_tr_b16 v[28:29], v43 offset:0
    ds_read_b64_tr_b16 v[30:31], v43 offset:1024
    buffer_load_dwordx4 v37, s[20:23], s29 offen offset:1024 lds
    s_add_u32 s29, s29, 131072
    s_waitcnt lgkmcnt(14)
    v_mfma_f32_16x16x32_bf16 v[64:67], v[48:51], v[216:219], v[64:67]
    s_waitcnt lgkmcnt(12)
    v_mfma_f32_16x16x32_bf16 v[72:75], v[52:55], v[216:219], v[72:75]
    s_waitcnt lgkmcnt(10)
    v_mfma_f32_16x16x32_bf16 v[80:83], v[56:59], v[216:219], v[80:83]
    s_waitcnt lgkmcnt(8)
    v_mfma_f32_16x16x32_bf16 v[88:91], v[60:63], v[216:219], v[88:91]
    s_add_u32 m0, s30, 114688
    s_nop 0
    buffer_load_dwordx4 v36, s[20:23], s29 offen lds
    v_mfma_f32_16x16x32_bf16 v[68:71], v[48:51], v[220:223], v[68:71]
    ds_read_b64_tr_b16 v[48:49], v40 offset:4096
    ds_read_b64_tr_b16 v[50:51], v40 offset:5120
    v_mfma_f32_16x16x32_bf16 v[76:79], v[52:55], v[220:223], v[76:79]
    ds_read_b64_tr_b16 v[52:53], v41 offset:4096
    ds_read_b64_tr_b16 v[54:55], v41 offset:5120
    v_mfma_f32_16x16x32_bf16 v[84:87], v[56:59], v[220:223], v[84:87]
    ds_read_b64_tr_b16 v[56:57], v42 offset:4096
    ds_read_b64_tr_b16 v[58:59], v42 offset:5120
    v_mfma_f32_16x16x32_bf16 v[92:95], v[60:63], v[220:223], v[92:95]
    ds_read_b64_tr_b16 v[60:61], v43 offset:4096
    ds_read_b64_tr_b16 v[62:63], v43 offset:5120
    buffer_load_dwordx4 v37, s[20:23], s29 offen offset:1024 lds
    s_add_u32 s29, s29, 131072
    s_barrier
    buffer_load_dwordx2 v[46:47], v45, s[32:35], s83 offen sc1
    s_waitcnt lgkmcnt(14)
    v_mfma_f32_16x16x32_bf16 v[64:67], v[16:19], v[224:227], v[64:67]
    s_waitcnt lgkmcnt(12)
    v_mfma_f32_16x16x32_bf16 v[72:75], v[20:23], v[224:227], v[72:75]
    s_waitcnt lgkmcnt(10)
    v_mfma_f32_16x16x32_bf16 v[80:83], v[24:27], v[224:227], v[80:83]
    s_waitcnt lgkmcnt(8)
    v_mfma_f32_16x16x32_bf16 v[88:91], v[28:31], v[224:227], v[88:91]
    v_add_u32 v40, 16384, v38
    v_xor_b32 v41, 32, v40
    v_xor_b32 v42, 64, v40
    v_xor_b32 v43, 0x60, v40
    s_add_u32 m0, s30, 131072
    s_nop 0
    buffer_load_dwordx4 v36, s[20:23], s29 offen lds
    v_mfma_f32_16x16x32_bf16 v[68:71], v[16:19], v[228:231], v[68:71]
    ds_read_b64_tr_b16 v[16:17], v40 offset:0
    ds_read_b64_tr_b16 v[18:19], v40 offset:1024
    v_mfma_f32_16x16x32_bf16 v[76:79], v[20:23], v[228:231], v[76:79]
    ds_read_b64_tr_b16 v[20:21], v41 offset:0
    ds_read_b64_tr_b16 v[22:23], v41 offset:1024
    v_mfma_f32_16x16x32_bf16 v[84:87], v[24:27], v[228:231], v[84:87]
    ds_read_b64_tr_b16 v[24:25], v42 offset:0
    ds_read_b64_tr_b16 v[26:27], v42 offset:1024
    v_mfma_f32_16x16x32_bf16 v[92:95], v[28:31], v[228:231], v[92:95]
    ds_read_b64_tr_b16 v[28:29], v43 offset:0
    ds_read_b64_tr_b16 v[30:31], v43 offset:1024
    buffer_load_dwordx4 v37, s[20:23], s29 offen offset:1024 lds
    s_add_u32 s29, s29, 131072
    s_waitcnt lgkmcnt(14)
    v_mfma_f32_16x16x32_bf16 v[64:67], v[48:51], v[232:235], v[64:67]
    s_waitcnt lgkmcnt(12)
    v_mfma_f32_16x16x32_bf16 v[72:75], v[52:55], v[232:235], v[72:75]
    s_waitcnt lgkmcnt(10)
    v_mfma_f32_16x16x32_bf16 v[80:83], v[56:59], v[232:235], v[80:83]
    s_waitcnt lgkmcnt(8)
    v_mfma_f32_16x16x32_bf16 v[88:91], v[60:63], v[232:235], v[88:91]
    s_add_u32 m0, s30, 147456
    s_nop 0
    buffer_load_dwordx4 v36, s[20:23], s29 offen lds
    v_mfma_f32_16x16x32_bf16 v[68:71], v[48:51], v[236:239], v[68:71]
    ds_read_b64_tr_b16 v[48:49], v40 offset:4096
    ds_read_b64_tr_b16 v[50:51], v40 offset:5120
    v_mfma_f32_16x16x32_bf16 v[76:79], v[52:55], v[236:239], v[76:79]
    ds_read_b64_tr_b16 v[52:53], v41 offset:4096
    ds_read_b64_tr_b16 v[54:55], v41 offset:5120
    v_mfma_f32_16x16x32_bf16 v[84:87], v[56:59], v[236:239], v[84:87]
    ds_read_b64_tr_b16 v[56:57], v42 offset:4096
    ds_read_b64_tr_b16 v[58:59], v42 offset:5120
    v_mfma_f32_16x16x32_bf16 v[92:95], v[60:63], v[236:239], v[92:95]
    ds_read_b64_tr_b16 v[60:61], v43 offset:4096
    ds_read_b64_tr_b16 v[62:63], v43 offset:5120
    buffer_load_dwordx4 v37, s[20:23], s29 offen offset:1024 lds
    s_add_u32 s29, s29, 131072
    s_waitcnt lgkmcnt(14)
    v_mfma_f32_16x16x32_bf16 v[64:67], v[16:19], v[240:243], v[64:67]
    s_waitcnt lgkmcnt(12)
    v_mfma_f32_16x16x32_bf16 v[72:75], v[20:23], v[240:243], v[72:75]
    s_waitcnt lgkmcnt(10)
    v_mfma_f32_16x16x32_bf16 v[80:83], v[24:27], v[240:243], v[80:83]
    s_waitcnt lgkmcnt(8)
    v_mfma_f32_16x16x32_bf16 v[88:91], v[28:31], v[240:243], v[88:91]
    v_mfma_f32_16x16x32_bf16 v[68:71], v[16:19], v[244:247], v[68:71]
    v_mfma_f32_16x16x32_bf16 v[76:79], v[20:23], v[244:247], v[76:79]
    v_mfma_f32_16x16x32_bf16 v[84:87], v[24:27], v[244:247], v[84:87]
    v_mfma_f32_16x16x32_bf16 v[92:95], v[28:31], v[244:247], v[92:95]
    s_waitcnt lgkmcnt(6)
    v_mfma_f32_16x16x32_bf16 v[64:67], v[48:51], v[248:251], v[64:67]
    s_waitcnt lgkmcnt(4)
    v_mfma_f32_16x16x32_bf16 v[72:75], v[52:55], v[248:251], v[72:75]
    s_waitcnt lgkmcnt(2)
    v_mfma_f32_16x16x32_bf16 v[80:83], v[56:59], v[248:251], v[80:83]
    s_waitcnt lgkmcnt(0)
    v_mfma_f32_16x16x32_bf16 v[88:91], v[60:63], v[248:251], v[88:91]
    v_mfma_f32_16x16x32_bf16 v[68:71], v[48:51], v[252:255], v[68:71]
    v_mfma_f32_16x16x32_bf16 v[76:79], v[52:55], v[252:255], v[76:79]
    v_mfma_f32_16x16x32_bf16 v[84:87], v[56:59], v[252:255], v[84:87]
    v_mfma_f32_16x16x32_bf16 v[92:95], v[60:63], v[252:255], v[92:95]
    s_waitcnt vmcnt(0)
    s_barrier
    v_and_b32 v46, v46, v47
    v_cmp_eq_u32 vcc, 1, v46
    s_cmp_eq_u64 vcc, -1
    s_cbranch_scc1 PB_OK_22
    s_mov_b32 s82, 0
PB_SP_23:
    s_sleep 2
    buffer_load_dwordx2 v[46:47], v45, s[32:35], s83 offen sc1
    s_add_u32 s82, s82, 1
    s_waitcnt vmcnt(0)
    v_and_b32 v46, v46, v47
    v_cmp_eq_u32 vcc, 1, v46
    s_cmp_eq_u64 vcc, -1
    s_cbranch_scc1 PB_OK_22
    s_cmp_lt_u32 s82, 65536
    s_cbranch_scc1 PB_SP_23
PB_OK_22:
    s_add_u32 s28, s28, 4161536
    buffer_load_dwordx4 v[128:131], v39, s[32:35], s28 offen offset:0 sc1
    buffer_load_dwordx4 v[132:135], v39, s[32:35], s28 offen offset:256 sc1
    buffer_load_dwordx4 v[136:139], v39, s[32:35], s28 offen offset:2048 sc1
    buffer_load_dwordx4 v[140:143], v39, s[32:35], s28 offen offset:2304 sc1
    v_sub_f32 v34, 1.0, v32
    v_sub_f32 v46, 1.0, v35
    s_lshl_b32 s38, s19, 13
    s_add_u32 s38, s38, 0
    v_lshl_add_u32 v4, v0, 4, s38
    v_and_b32 v5, 15, v0
    s_lshl_b32 s38, s16, 7
    s_lshl_b32 s47, s19, 5
    s_add_u32 s38, s38, s47
    v_add_u32 v5, s38, v5
    v_lshlrev_b32 v5, 11, v5
    v_lshrrev_b32 v6, 4, v0
    v_lshl_add_u32 v5, v6, 4, v5
    s_lshl_b32 s38, s17, 7
    v_add_u32 v5, s38, v5
    v_add_u32 v6, 32768, v5
    v_pk_mul_f32 v[64:65], v[64:65], v[32:33] op_sel_hi:[1,0]
    v_pk_mul_f32 v[66:67], v[66:67], v[32:33] op_sel_hi:[1,0]
    v_pk_mul_f32 v[68:69], v[68:69], v[34:35] op_sel:[0,1] op_sel_hi:[1,1]
    v_pk_mul_f32 v[70:71], v[70:71], v[34:35] op_sel:[0,1] op_sel_hi:[1,1]
    v_pk_mul_f32 v[72:73], v[72:73], v[32:33] op_sel_hi:[1,0]
    v_pk_mul_f32 v[74:75], v[74:75], v[32:33] op_sel_hi:[1,0]
    v_pk_mul_f32 v[76:77], v[76:77], v[34:35] op_sel:[0,1] op_sel_hi:[1,1]
    v_pk_mul_f32 v[78:79], v[78:79], v[34:35] op_sel:[0,1] op_sel_hi:[1,1]
    v_pk_mul_f32 v[80:81], v[80:81], v[32:33] op_sel_hi:[1,0]
    v_pk_mul_f32 v[82:83], v[82:83], v[32:33] op_sel_hi:[1,0]
    v_pk_mul_f32 v[84:85], v[84:85], v[34:35] op_sel:[0,1] op_sel_hi:[1,1]
    v_pk_mul_f32 v[86:87], v[86:87], v[34:35] op_sel:[0,1] op_sel_hi:[1,1]
    v_pk_mul_f32 v[88:89], v[88:89], v[32:33] op_sel_hi:[1,0]
    v_pk_mul_f32 v[90:91], v[90:91], v[32:33] op_sel_hi:[1,0]
    v_pk_mul_f32 v[92:93], v[92:93], v[34:35] op_sel:[0,1] op_sel_hi:[1,1]
    v_pk_mul_f32 v[94:95], v[94:95], v[34:35] op_sel:[0,1] op_sel_hi:[1,1]
    s_mov_b32 s24, s8
    s_mov_b32 s25, s9
    s_mov_b32 s26, 4194304
    s_mov_b32 s27, 0x00020000
    v_add_u32 v40, 32768, v38
    v_xor_b32 v41, 32, v40
    v_xor_b32 v42, 64, v40
    v_xor_b32 v43, 0x60, v40
    s_nop 0
    ds_read_b64_tr_b16 v[16:17], v40 offset:0
    ds_read_b64_tr_b16 v[18:19], v40 offset:1024
    ds_read_b64_tr_b16 v[20:21], v41 offset:0
    ds_read_b64_tr_b16 v[22:23], v41 offset:1024
    ds_read_b64_tr_b16 v[24:25], v42 offset:0
    ds_read_b64_tr_b16 v[26:27], v42 offset:1024
    ds_read_b64_tr_b16 v[28:29], v43 offset:0
    ds_read_b64_tr_b16 v[30:31], v43 offset:1024
    ds_read_b64_tr_b16 v[48:49], v40 offset:4096
    ds_read_b64_tr_b16 v[50:51], v40 offset:5120
    ds_read_b64_tr_b16 v[52:53], v41 offset:4096
    ds_read_b64_tr_b16 v[54:55], v41 offset:5120
    ds_read_b64_tr_b16 v[56:57], v42 offset:4096
    ds_read_b64_tr_b16 v[58:59], v42 offset:5120
    ds_read_b64_tr_b16 v[60:61], v43 offset:4096
    ds_read_b64_tr_b16 v[62:63], v43 offset:5120
    s_waitcnt vmcnt(3)
    s_waitcnt lgkmcnt(14)
    v_mfma_f32_16x16x32_bf16 v[96:99], v[16:19], v[128:131], 0
    s_waitcnt lgkmcnt(12)
    v_mfma_f32_16x16x32_bf16 v[104:107], v[20:23], v[128:131], 0
    s_waitcnt lgkmcnt(10)
    v_mfma_f32_16x16x32_bf16 v[112:115], v[24:27], v[128:131], 0
    s_waitcnt lgkmcnt(8)
    v_mfma_f32_16x16x32_bf16 v[120:123], v[28:31], v[128:131], 0
    v_add_u32 v40, 49152, v38
    v_xor_b32 v41, 32, v40
    v_xor_b32 v42, 64, v40
    v_xor_b32 v43, 0x60, v40
    s_add_u32 s28, s28, 4096
    buffer_load_dwordx4 v[144:147], v39, s[32:35], s28 offen offset:0 sc1
    s_waitcnt vmcnt(3)
    v_mfma_f32_16x16x32_bf16 v[100:103], v[16:19], v[132:135], 0
    ds_read_b64_tr_b16 v[16:17], v40 offset:0
    ds_read_b64_tr_b16 v[18:19], v40 offset:1024
    v_mfma_f32_16x16x32_bf16 v[108:111], v[20:23], v[132:135], 0
    ds_read_b64_tr_b16 v[20:21], v41 offset:0
    ds_read_b64_tr_b16 v[22:23], v41 offset:1024
    v_mfma_f32_16x16x32_bf16 v[116:119], v[24:27], v[132:135], 0
    ds_read_b64_tr_b16 v[24:25], v42 offset:0
    ds_read_b64_tr_b16 v[26:27], v42 offset:1024
    v_mfma_f32_16x16x32_bf16 v[124:127], v[28:31], v[132:135], 0
    ds_read_b64_tr_b16 v[28:29], v43 offset:0
    ds_read_b64_tr_b16 v[30:31], v43 offset:1024
    buffer_load_dwordx4 v[148:151], v39, s[32:35], s28 offen offset:256 sc1
    buffer_load_dwordx4 v[152:155], v39, s[32:35], s28 offen offset:2048 sc1
    s_waitcnt vmcnt(4)
    s_waitcnt lgkmcnt(14)
    v_mfma_f32_16x16x32_bf16 v[96:99], v[48:51], v[136:139], v[96:99]
    s_waitcnt lgkmcnt(12)
    v_mfma_f32_16x16x32_bf16 v[104:107], v[52:55], v[136:139], v[104:107]
    s_waitcnt lgkmcnt(10)
    v_mfma_f32_16x16x32_bf16 v[112:115], v[56:59], v[136:139], v[112:115]
    s_waitcnt lgkmcnt(8)
    v_mfma_f32_16x16x32_bf16 v[120:123], v[60:63], v[136:139], v[120:123]
    buffer_load_dwordx4 v[156:159], v39, s[32:35], s28 offen offset:2304 sc1
    s_add_u32 s28, s28, 4096
    buffer_load_dwordx4 v[160:163], v39, s[32:35], s28 offen offset:0 sc1
    s_waitcnt vmcnt(5)
    v_mfma_f32_16x16x32_bf16 v[100:103], v[48:51], v[140:143], v[100:103]
    ds_read_b64_tr_b16 v[48:49], v40 offset:4096
    ds_read_b64_tr_b16 v[50:51], v40 offset:5120
    v_mfma_f32_16x16x32_bf16 v[108:111], v[52:55], v[140:143], v[108:111]
    ds_read_b64_tr_b16 v[52:53], v41 offset:4096
    ds_read_b64_tr_b16 v[54:55], v41 offset:5120
    v_mfma_f32_16x16x32_bf16 v[116:119], v[56:59], v[140:143], v[116:119]
    ds_read_b64_tr_b16 v[56:57], v42 offset:4096
    ds_read_b64_tr_b16 v[58:59], v42 offset:5120
    v_mfma_f32_16x16x32_bf16 v[124:127], v[60:63], v[140:143], v[124:127]
    ds_read_b64_tr_b16 v[60:61], v43 offset:4096
    ds_read_b64_tr_b16 v[62:63], v43 offset:5120
    buffer_load_dwordx4 v[164:167], v39, s[32:35], s28 offen offset:256 sc1
    s_waitcnt vmcnt(5)
    s_waitcnt lgkmcnt(14)
    v_mfma_f32_16x16x32_bf16 v[96:99], v[16:19], v[144:147], v[96:99]
    s_waitcnt lgkmcnt(12)
    v_mfma_f32_16x16x32_bf16 v[104:107], v[20:23], v[144:147], v[104:107]
    s_waitcnt lgkmcnt(10)
    v_mfma_f32_16x16x32_bf16 v[112:115], v[24:27], v[144:147], v[112:115]
    s_waitcnt lgkmcnt(8)
    v_mfma_f32_16x16x32_bf16 v[120:123], v[28:31], v[144:147], v[120:123]
    v_add_u32 v40, 65536, v38
    v_xor_b32 v41, 32, v40
    v_xor_b32 v42, 64, v40
    v_xor_b32 v43, 0x60, v40
    buffer_load_dwordx4 v[168:171], v39, s[32:35], s28 offen offset:2048 sc1
    s_waitcnt vmcnt(5)
    v_mfma_f32_16x16x32_bf16 v[100:103], v[16:19], v[148:151], v[100:103]
    ds_read_b64_tr_b16 v[16:17], v40 offset:0
    ds_read_b64_tr_b16 v[18:19], v40 offset:1024
    v_mfma_f32_16x16x32_bf16 v[108:111], v[20:23], v[148:151], v[108:111]
    ds_read_b64_tr_b16 v[20:21], v41 offset:0
    ds_read_b64_tr_b16 v[22:23], v41 offset:1024
    v_mfma_f32_16x16x32_bf16 v[116:119], v[24:27], v[148:151], v[116:119]
    ds_read_b64_tr_b16 v[24:25], v42 offset:0
    ds_read_b64_tr_b16 v[26:27], v42 offset:1024
    v_mfma_f32_16x16x32_bf16 v[124:127], v[28:31], v[148:151], v[124:127]
    ds_read_b64_tr_b16 v[28:29], v43 offset:0
    ds_read_b64_tr_b16 v[30:31], v43 offset:1024
    buffer_load_dwordx4 v[172:175], v39, s[32:35], s28 offen offset:2304 sc1
    s_waitcnt vmcnt(5)
    s_waitcnt lgkmcnt(14)
    v_mfma_f32_16x16x32_bf16 v[96:99], v[48:51], v[152:155], v[96:99]
    s_waitcnt lgkmcnt(12)
    v_mfma_f32_16x16x32_bf16 v[104:107], v[52:55], v[152:155], v[104:107]
    s_waitcnt lgkmcnt(10)
    v_mfma_f32_16x16x32_bf16 v[112:115], v[56:59], v[152:155], v[112:115]
    s_waitcnt lgkmcnt(8)
    v_mfma_f32_16x16x32_bf16 v[120:123], v[60:63], v[152:155], v[120:123]
    s_add_u32 s28, s28, 4096
    buffer_load_dwordx4 v[176:179], v39, s[32:35], s28 offen offset:0 sc1
    s_waitcnt vmcnt(5)
    v_mfma_f32_16x16x32_bf16 v[100:103], v[48:51], v[156:159], v[100:103]
    ds_read_b64_tr_b16 v[48:49], v40 offset:4096
    ds_read_b64_tr_b16 v[50:51], v40 offset:5120
    v_mfma_f32_16x16x32_bf16 v[108:111], v[52:55], v[156:159], v[108:111]
    ds_read_b64_tr_b16 v[52:53], v41 offset:4096
    ds_read_b64_tr_b16 v[54:55], v41 offset:5120
    v_mfma_f32_16x16x32_bf16 v[116:119], v[56:59], v[156:159], v[116:119]
    ds_read_b64_tr_b16 v[56:57], v42 offset:4096
    ds_read_b64_tr_b16 v[58:59], v42 offset:5120
    v_mfma_f32_16x16x32_bf16 v[124:127], v[60:63], v[156:159], v[124:127]
    ds_read_b64_tr_b16 v[60:61], v43 offset:4096
    ds_read_b64_tr_b16 v[62:63], v43 offset:5120
    buffer_load_dwordx4 v[180:183], v39, s[32:35], s28 offen offset:256 sc1
    s_waitcnt vmcnt(5)
    s_waitcnt lgkmcnt(14)
    v_mfma_f32_16x16x32_bf16 v[96:99], v[16:19], v[160:163], v[96:99]
    s_waitcnt lgkmcnt(12)
    v_mfma_f32_16x16x32_bf16 v[104:107], v[20:23], v[160:163], v[104:107]
    s_waitcnt lgkmcnt(10)
    v_mfma_f32_16x16x32_bf16 v[112:115], v[24:27], v[160:163], v[112:115]
    s_waitcnt lgkmcnt(8)
    v_mfma_f32_16x16x32_bf16 v[120:123], v[28:31], v[160:163], v[120:123]
    v_add_u32 v40, 81920, v38
    v_xor_b32 v41, 32, v40
    v_xor_b32 v42, 64, v40
    v_xor_b32 v43, 0x60, v40
    buffer_load_dwordx4 v[184:187], v39, s[32:35], s28 offen offset:2048 sc1
    s_waitcnt vmcnt(5)
    v_mfma_f32_16x16x32_bf16 v[100:103], v[16:19], v[164:167], v[100:103]
    ds_read_b64_tr_b16 v[16:17], v40 offset:0
    ds_read_b64_tr_b16 v[18:19], v40 offset:1024
    v_mfma_f32_16x16x32_bf16 v[108:111], v[20:23], v[164:167], v[108:111]
    ds_read_b64_tr_b16 v[20:21], v41 offset:0
    ds_read_b64_tr_b16 v[22:23], v41 offset:1024
    v_mfma_f32_16x16x32_bf16 v[116:119], v[24:27], v[164:167], v[116:119]
    ds_read_b64_tr_b16 v[24:25], v42 offset:0
    ds_read_b64_tr_b16 v[26:27], v42 offset:1024
    v_mfma_f32_16x16x32_bf16 v[124:127], v[28:31], v[164:167], v[124:127]
    ds_read_b64_tr_b16 v[28:29], v43 offset:0
    ds_read_b64_tr_b16 v[30:31], v43 offset:1024
    buffer_load_dwordx4 v[188:191], v39, s[32:35], s28 offen offset:2304 sc1
    s_waitcnt vmcnt(5)
    s_waitcnt lgkmcnt(14)
    v_mfma_f32_16x16x32_bf16 v[96:99], v[48:51], v[168:171], v[96:99]
    s_waitcnt lgkmcnt(12)
    v_mfma_f32_16x16x32_bf16 v[104:107], v[52:55], v[168:171], v[104:107]
    s_waitcnt lgkmcnt(10)
    v_mfma_f32_16x16x32_bf16 v[112:115], v[56:59], v[168:171], v[112:115]
    s_waitcnt lgkmcnt(8)
    v_mfma_f32_16x16x32_bf16 v[120:123], v[60:63], v[168:171], v[120:123]
    s_add_u32 s28, s28, 4096
    buffer_load_dwordx4 v[192:195], v39, s[32:35], s28 offen offset:0 sc1
    s_waitcnt vmcnt(5)
    v_mfma_f32_16x16x32_bf16 v[100:103], v[48:51], v[172:175], v[100:103]
    ds_read_b64_tr_b16 v[48:49], v40 offset:4096
    ds_read_b64_tr_b16 v[50:51], v40 offset:5120
    v_mfma_f32_16x16x32_bf16 v[108:111], v[52:55], v[172:175], v[108:111]
    ds_read_b64_tr_b16 v[52:53], v41 offset:4096
    ds_read_b64_tr_b16 v[54:55], v41 offset:5120
    v_mfma_f32_16x16x32_bf16 v[116:119], v[56:59], v[172:175], v[116:119]
    ds_read_b64_tr_b16 v[56:57], v42 offset:4096
    ds_read_b64_tr_b16 v[58:59], v42 offset:5120
    v_mfma_f32_16x16x32_bf16 v[124:127], v[60:63], v[172:175], v[124:127]
    ds_read_b64_tr_b16 v[60:61], v43 offset:4096
    ds_read_b64_tr_b16 v[62:63], v43 offset:5120
    buffer_load_dwordx4 v[196:199], v39, s[32:35], s28 offen offset:256 sc1
    s_waitcnt vmcnt(5)
    s_waitcnt lgkmcnt(14)
    v_mfma_f32_16x16x32_bf16 v[96:99], v[16:19], v[176:179], v[96:99]
    s_waitcnt lgkmcnt(12)
    v_mfma_f32_16x16x32_bf16 v[104:107], v[20:23], v[176:179], v[104:107]
    s_waitcnt lgkmcnt(10)
    v_mfma_f32_16x16x32_bf16 v[112:115], v[24:27], v[176:179], v[112:115]
    s_waitcnt lgkmcnt(8)
    v_mfma_f32_16x16x32_bf16 v[120:123], v[28:31], v[176:179], v[120:123]
    v_add_u32 v40, 98304, v38
    v_xor_b32 v41, 32, v40
    v_xor_b32 v42, 64, v40
    v_xor_b32 v43, 0x60, v40
    buffer_load_dwordx4 v[200:203], v39, s[32:35], s28 offen offset:2048 sc1
    s_waitcnt vmcnt(5)
    v_mfma_f32_16x16x32_bf16 v[100:103], v[16:19], v[180:183], v[100:103]
    ds_read_b64_tr_b16 v[16:17], v40 offset:0
    ds_read_b64_tr_b16 v[18:19], v40 offset:1024
    v_mfma_f32_16x16x32_bf16 v[108:111], v[20:23], v[180:183], v[108:111]
    ds_read_b64_tr_b16 v[20:21], v41 offset:0
    ds_read_b64_tr_b16 v[22:23], v41 offset:1024
    v_mfma_f32_16x16x32_bf16 v[116:119], v[24:27], v[180:183], v[116:119]
    ds_read_b64_tr_b16 v[24:25], v42 offset:0
    ds_read_b64_tr_b16 v[26:27], v42 offset:1024
    v_mfma_f32_16x16x32_bf16 v[124:127], v[28:31], v[180:183], v[124:127]
    ds_read_b64_tr_b16 v[28:29], v43 offset:0
    ds_read_b64_tr_b16 v[30:31], v43 offset:1024
    buffer_load_dwordx4 v[204:207], v39, s[32:35], s28 offen offset:2304 sc1
    s_waitcnt vmcnt(5)
    s_waitcnt lgkmcnt(14)
    v_mfma_f32_16x16x32_bf16 v[96:99], v[48:51], v[184:187], v[96:99]
    s_waitcnt lgkmcnt(12)
    v_mfma_f32_16x16x32_bf16 v[104:107], v[52:55], v[184:187], v[104:107]
    s_waitcnt lgkmcnt(10)
    v_mfma_f32_16x16x32_bf16 v[112:115], v[56:59], v[184:187], v[112:115]
    s_waitcnt lgkmcnt(8)
    v_mfma_f32_16x16x32_bf16 v[120:123], v[60:63], v[184:187], v[120:123]
    s_add_u32 s28, s28, 4096
    buffer_load_dwordx4 v[208:211], v39, s[32:35], s28 offen offset:0 sc1
    s_waitcnt vmcnt(5)
    v_mfma_f32_16x16x32_bf16 v[100:103], v[48:51], v[188:191], v[100:103]
    ds_read_b64_tr_b16 v[48:49], v40 offset:4096
    ds_read_b64_tr_b16 v[50:51], v40 offset:5120
    v_mfma_f32_16x16x32_bf16 v[108:111], v[52:55], v[188:191], v[108:111]
    ds_read_b64_tr_b16 v[52:53], v41 offset:4096
    ds_read_b64_tr_b16 v[54:55], v41 offset:5120
    v_mfma_f32_16x16x32_bf16 v[116:119], v[56:59], v[188:191], v[116:119]
    ds_read_b64_tr_b16 v[56:57], v42 offset:4096
    ds_read_b64_tr_b16 v[58:59], v42 offset:5120
    v_mfma_f32_16x16x32_bf16 v[124:127], v[60:63], v[188:191], v[124:127]
    ds_read_b64_tr_b16 v[60:61], v43 offset:4096
    ds_read_b64_tr_b16 v[62:63], v43 offset:5120
    buffer_load_dwordx4 v[212:215], v39, s[32:35], s28 offen offset:256 sc1
    s_waitcnt vmcnt(5)
    s_waitcnt lgkmcnt(14)
    v_mfma_f32_16x16x32_bf16 v[96:99], v[16:19], v[192:195], v[96:99]
    s_waitcnt lgkmcnt(12)
    v_mfma_f32_16x16x32_bf16 v[104:107], v[20:23], v[192:195], v[104:107]
    s_waitcnt lgkmcnt(10)
    v_mfma_f32_16x16x32_bf16 v[112:115], v[24:27], v[192:195], v[112:115]
    s_waitcnt lgkmcnt(8)
    v_mfma_f32_16x16x32_bf16 v[120:123], v[28:31], v[192:195], v[120:123]
    v_add_u32 v40, 114688, v38
    v_xor_b32 v41, 32, v40
    v_xor_b32 v42, 64, v40
    v_xor_b32 v43, 0x60, v40
    buffer_load_dwordx4 v[216:219], v39, s[32:35], s28 offen offset:2048 sc1
    s_waitcnt vmcnt(5)
    v_mfma_f32_16x16x32_bf16 v[100:103], v[16:19], v[196:199], v[100:103]
    ds_read_b64_tr_b16 v[16:17], v40 offset:0
    ds_read_b64_tr_b16 v[18:19], v40 offset:1024
    v_mfma_f32_16x16x32_bf16 v[108:111], v[20:23], v[196:199], v[108:111]
    ds_read_b64_tr_b16 v[20:21], v41 offset:0
    ds_read_b64_tr_b16 v[22:23], v41 offset:1024
    v_mfma_f32_16x16x32_bf16 v[116:119], v[24:27], v[196:199], v[116:119]
    ds_read_b64_tr_b16 v[24:25], v42 offset:0
    ds_read_b64_tr_b16 v[26:27], v42 offset:1024
    v_mfma_f32_16x16x32_bf16 v[124:127], v[28:31], v[196:199], v[124:127]
    ds_read_b64_tr_b16 v[28:29], v43 offset:0
    ds_read_b64_tr_b16 v[30:31], v43 offset:1024
    buffer_load_dwordx4 v[220:223], v39, s[32:35], s28 offen offset:2304 sc1
    s_waitcnt vmcnt(5)
    s_waitcnt lgkmcnt(14)
    v_mfma_f32_16x16x32_bf16 v[96:99], v[48:51], v[200:203], v[96:99]
    s_waitcnt lgkmcnt(12)
    v_mfma_f32_16x16x32_bf16 v[104:107], v[52:55], v[200:203], v[104:107]
    s_waitcnt lgkmcnt(10)
    v_mfma_f32_16x16x32_bf16 v[112:115], v[56:59], v[200:203], v[112:115]
    s_waitcnt lgkmcnt(8)
    v_mfma_f32_16x16x32_bf16 v[120:123], v[60:63], v[200:203], v[120:123]
    s_add_u32 s28, s28, 4096
    buffer_load_dwordx4 v[224:227], v39, s[32:35], s28 offen offset:0 sc1
    s_waitcnt vmcnt(5)
    v_mfma_f32_16x16x32_bf16 v[100:103], v[48:51], v[204:207], v[100:103]
    ds_read_b64_tr_b16 v[48:49], v40 offset:4096
    ds_read_b64_tr_b16 v[50:51], v40 offset:5120
    v_mfma_f32_16x16x32_bf16 v[108:111], v[52:55], v[204:207], v[108:111]
    ds_read_b64_tr_b16 v[52:53], v41 offset:4096
    ds_read_b64_tr_b16 v[54:55], v41 offset:5120
    v_mfma_f32_16x16x32_bf16 v[116:119], v[56:59], v[204:207], v[116:119]
    ds_read_b64_tr_b16 v[56:57], v42 offset:4096
    ds_read_b64_tr_b16 v[58:59], v42 offset:5120
    v_mfma_f32_16x16x32_bf16 v[124:127], v[60:63], v[204:207], v[124:127]
    ds_read_b64_tr_b16 v[60:61], v43 offset:4096
    ds_read_b64_tr_b16 v[62:63], v43 offset:5120
    buffer_load_dwordx4 v[228:231], v39, s[32:35], s28 offen offset:256 sc1
    s_waitcnt vmcnt(5)
    s_waitcnt lgkmcnt(14)
    v_mfma_f32_16x16x32_bf16 v[96:99], v[16:19], v[208:211], v[96:99]
    s_waitcnt lgkmcnt(12)
    v_mfma_f32_16x16x32_bf16 v[104:107], v[20:23], v[208:211], v[104:107]
    s_waitcnt lgkmcnt(10)
    v_mfma_f32_16x16x32_bf16 v[112:115], v[24:27], v[208:211], v[112:115]
    s_waitcnt lgkmcnt(8)
    v_mfma_f32_16x16x32_bf16 v[120:123], v[28:31], v[208:211], v[120:123]
    v_add_u32 v40, 131072, v38
    v_xor_b32 v41, 32, v40
    v_xor_b32 v42, 64, v40
    v_xor_b32 v43, 0x60, v40
    buffer_load_dwordx4 v[232:235], v39, s[32:35], s28 offen offset:2048 sc1
    s_waitcnt vmcnt(5)
    v_mfma_f32_16x16x32_bf16 v[100:103], v[16:19], v[212:215], v[100:103]
    ds_read_b64_tr_b16 v[16:17], v40 offset:0
    ds_read_b64_tr_b16 v[18:19], v40 offset:1024
    v_mfma_f32_16x16x32_bf16 v[108:111], v[20:23], v[212:215], v[108:111]
    ds_read_b64_tr_b16 v[20:21], v41 offset:0
    ds_read_b64_tr_b16 v[22:23], v41 offset:1024
    v_mfma_f32_16x16x32_bf16 v[116:119], v[24:27], v[212:215], v[116:119]
    ds_read_b64_tr_b16 v[24:25], v42 offset:0
    ds_read_b64_tr_b16 v[26:27], v42 offset:1024
    v_mfma_f32_16x16x32_bf16 v[124:127], v[28:31], v[212:215], v[124:127]
    ds_read_b64_tr_b16 v[28:29], v43 offset:0
    ds_read_b64_tr_b16 v[30:31], v43 offset:1024
    buffer_load_dwordx4 v[236:239], v39, s[32:35], s28 offen offset:2304 sc1
    s_waitcnt vmcnt(5)
    s_waitcnt lgkmcnt(14)
    v_mfma_f32_16x16x32_bf16 v[96:99], v[48:51], v[216:219], v[96:99]
    s_waitcnt lgkmcnt(12)
    v_mfma_f32_16x16x32_bf16 v[104:107], v[52:55], v[216:219], v[104:107]
    s_waitcnt lgkmcnt(10)
    v_mfma_f32_16x16x32_bf16 v[112:115], v[56:59], v[216:219], v[112:115]
    s_waitcnt lgkmcnt(8)
    v_mfma_f32_16x16x32_bf16 v[120:123], v[60:63], v[216:219], v[120:123]
    s_add_u32 s28, s28, 4096
    buffer_load_dwordx4 v[240:243], v39, s[32:35], s28 offen offset:0 sc1
    s_waitcnt vmcnt(5)
    v_mfma_f32_16x16x32_bf16 v[100:103], v[48:51], v[220:223], v[100:103]
    ds_read_b64_tr_b16 v[48:49], v40 offset:4096
    ds_read_b64_tr_b16 v[50:51], v40 offset:5120
    v_mfma_f32_16x16x32_bf16 v[108:111], v[52:55], v[220:223], v[108:111]
    ds_read_b64_tr_b16 v[52:53], v41 offset:4096
    ds_read_b64_tr_b16 v[54:55], v41 offset:5120
    v_mfma_f32_16x16x32_bf16 v[116:119], v[56:59], v[220:223], v[116:119]
    ds_read_b64_tr_b16 v[56:57], v42 offset:4096
    ds_read_b64_tr_b16 v[58:59], v42 offset:5120
    v_mfma_f32_16x16x32_bf16 v[124:127], v[60:63], v[220:223], v[124:127]
    ds_read_b64_tr_b16 v[60:61], v43 offset:4096
    ds_read_b64_tr_b16 v[62:63], v43 offset:5120
    buffer_load_dwordx4 v[244:247], v39, s[32:35], s28 offen offset:256 sc1
    s_waitcnt vmcnt(5)
    s_waitcnt lgkmcnt(14)
    v_mfma_f32_16x16x32_bf16 v[96:99], v[16:19], v[224:227], v[96:99]
    s_waitcnt lgkmcnt(12)
    v_mfma_f32_16x16x32_bf16 v[104:107], v[20:23], v[224:227], v[104:107]
    s_waitcnt lgkmcnt(10)
    v_mfma_f32_16x16x32_bf16 v[112:115], v[24:27], v[224:227], v[112:115]
    s_waitcnt lgkmcnt(8)
    v_mfma_f32_16x16x32_bf16 v[120:123], v[28:31], v[224:227], v[120:123]
    v_add_u32 v40, 147456, v38
    v_xor_b32 v41, 32, v40
    v_xor_b32 v42, 64, v40
    v_xor_b32 v43, 0x60, v40
    buffer_load_dwordx4 v[248:251], v39, s[32:35], s28 offen offset:2048 sc1
    s_waitcnt vmcnt(5)
    v_mfma_f32_16x16x32_bf16 v[100:103], v[16:19], v[228:231], v[100:103]
    ds_read_b64_tr_b16 v[16:17], v40 offset:0
    ds_read_b64_tr_b16 v[18:19], v40 offset:1024
    v_mfma_f32_16x16x32_bf16 v[108:111], v[20:23], v[228:231], v[108:111]
    ds_read_b64_tr_b16 v[20:21], v41 offset:0
    ds_read_b64_tr_b16 v[22:23], v41 offset:1024
    v_mfma_f32_16x16x32_bf16 v[116:119], v[24:27], v[228:231], v[116:119]
    ds_read_b64_tr_b16 v[24:25], v42 offset:0
    ds_read_b64_tr_b16 v[26:27], v42 offset:1024
    v_mfma_f32_16x16x32_bf16 v[124:127], v[28:31], v[228:231], v[124:127]
    ds_read_b64_tr_b16 v[28:29], v43 offset:0
    ds_read_b64_tr_b16 v[30:31], v43 offset:1024
    buffer_load_dwordx4 v[252:255], v39, s[32:35], s28 offen offset:2304 sc1
    s_waitcnt vmcnt(5)
    s_waitcnt lgkmcnt(14)
    v_mfma_f32_16x16x32_bf16 v[96:99], v[48:51], v[232:235], v[96:99]
    s_waitcnt lgkmcnt(12)
    v_mfma_f32_16x16x32_bf16 v[104:107], v[52:55], v[232:235], v[104:107]
    s_waitcnt lgkmcnt(10)
    v_mfma_f32_16x16x32_bf16 v[112:115], v[56:59], v[232:235], v[112:115]
    s_waitcnt lgkmcnt(8)
    v_mfma_f32_16x16x32_bf16 v[120:123], v[60:63], v[232:235], v[120:123]
    s_waitcnt vmcnt(4)
    v_mfma_f32_16x16x32_bf16 v[100:103], v[48:51], v[236:239], v[100:103]
    ds_read_b64_tr_b16 v[48:49], v40 offset:4096
    ds_read_b64_tr_b16 v[50:51], v40 offset:5120
    v_mfma_f32_16x16x32_bf16 v[108:111], v[52:55], v[236:239], v[108:111]
    ds_read_b64_tr_b16 v[52:53], v41 offset:4096
    ds_read_b64_tr_b16 v[54:55], v41 offset:5120
    v_mfma_f32_16x16x32_bf16 v[116:119], v[56:59], v[236:239], v[116:119]
    ds_read_b64_tr_b16 v[56:57], v42 offset:4096
    ds_read_b64_tr_b16 v[58:59], v42 offset:5120
    v_mfma_f32_16x16x32_bf16 v[124:127], v[60:63], v[236:239], v[124:127]
    ds_read_b64_tr_b16 v[60:61], v43 offset:4096
    ds_read_b64_tr_b16 v[62:63], v43 offset:5120
    s_waitcnt vmcnt(3)
    s_waitcnt lgkmcnt(14)
    v_mfma_f32_16x16x32_bf16 v[96:99], v[16:19], v[240:243], v[96:99]
    s_waitcnt lgkmcnt(12)
    v_mfma_f32_16x16x32_bf16 v[104:107], v[20:23], v[240:243], v[104:107]
    s_waitcnt lgkmcnt(10)
    v_mfma_f32_16x16x32_bf16 v[112:115], v[24:27], v[240:243], v[112:115]
    s_waitcnt lgkmcnt(8)
    v_mfma_f32_16x16x32_bf16 v[120:123], v[28:31], v[240:243], v[120:123]
    s_waitcnt vmcnt(2)
    v_mfma_f32_16x16x32_bf16 v[100:103], v[16:19], v[244:247], v[100:103]
    v_mfma_f32_16x16x32_bf16 v[108:111], v[20:23], v[244:247], v[108:111]
    v_mfma_f32_16x16x32_bf16 v[116:119], v[24:27], v[244:247], v[116:119]
    v_mfma_f32_16x16x32_bf16 v[124:127], v[28:31], v[244:247], v[124:127]
    s_cmp_eq_u32 s18, 0
    s_cbranch_scc1 K3_G0T
    s_barrier
    ds_read_b128 v[128:131], v4 offset:0
    ds_read_b128 v[132:135], v4 offset:1024
    ds_read_b128 v[136:139], v4 offset:2048
    ds_read_b128 v[140:143], v4 offset:3072
    ds_read_b128 v[144:147], v4 offset:4096
    ds_read_b128 v[148:151], v4 offset:5120
    ds_read_b128 v[152:155], v4 offset:6144
    ds_read_b128 v[156:159], v4 offset:7168
    s_waitcnt vmcnt(1)
    s_waitcnt lgkmcnt(14)
    v_mfma_f32_16x16x32_bf16 v[96:99], v[48:51], v[248:251], v[96:99]
    s_waitcnt lgkmcnt(12)
    v_mfma_f32_16x16x32_bf16 v[104:107], v[52:55], v[248:251], v[104:107]
    s_waitcnt lgkmcnt(10)
    v_mfma_f32_16x16x32_bf16 v[112:115], v[56:59], v[248:251], v[112:115]
    s_waitcnt lgkmcnt(8)
    v_mfma_f32_16x16x32_bf16 v[120:123], v[60:63], v[248:251], v[120:123]
    s_waitcnt vmcnt(0)
    v_mfma_f32_16x16x32_bf16 v[100:103], v[48:51], v[252:255], v[100:103]
    v_mfma_f32_16x16x32_bf16 v[108:111], v[52:55], v[252:255], v[108:111]
    v_mfma_f32_16x16x32_bf16 v[116:119], v[56:59], v[252:255], v[116:119]
    v_mfma_f32_16x16x32_bf16 v[124:127], v[60:63], v[252:255], v[124:127]
    s_waitcnt lgkmcnt(0)
    v_pk_add_f32 v[64:65], v[64:65], v[128:129]
    v_pk_add_f32 v[66:67], v[66:67], v[130:131]
    v_pk_add_f32 v[72:73], v[72:73], v[136:137]
    v_pk_add_f32 v[74:75], v[74:75], v[138:139]
    v_pk_add_f32 v[80:81], v[80:81], v[144:145]
    v_pk_add_f32 v[82:83], v[82:83], v[146:147]
    v_pk_add_f32 v[88:89], v[88:89], v[152:153]
    v_pk_add_f32 v[90:91], v[90:91], v[154:155]
    v_pk_add_f32 v[68:69], v[68:69], v[132:133]
    v_pk_add_f32 v[70:71], v[70:71], v[134:135]
    v_pk_add_f32 v[76:77], v[76:77], v[140:141]
    v_pk_add_f32 v[78:79], v[78:79], v[142:143]
    v_pk_add_f32 v[84:85], v[84:85], v[148:149]
    v_pk_add_f32 v[86:87], v[86:87], v[150:151]
    v_pk_add_f32 v[92:93], v[92:93], v[156:157]
    v_pk_add_f32 v[94:95], v[94:95], v[158:159]
    v_pk_fma_f32 v[64:65], v[96:97], v[34:35], v[64:65] op_sel_hi:[1,0,1]
    v_pk_fma_f32 v[66:67], v[98:99], v[34:35], v[66:67] op_sel_hi:[1,0,1]
    v_pk_fma_f32 v[72:73], v[104:105], v[34:35], v[72:73] op_sel_hi:[1,0,1]
    v_pk_fma_f32 v[74:75], v[106:107], v[34:35], v[74:75] op_sel_hi:[1,0,1]
    v_pk_fma_f32 v[80:81], v[112:113], v[34:35], v[80:81] op_sel_hi:[1,0,1]
    v_pk_fma_f32 v[82:83], v[114:115], v[34:35], v[82:83] op_sel_hi:[1,0,1]
    v_pk_fma_f32 v[88:89], v[120:121], v[34:35], v[88:89] op_sel_hi:[1,0,1]
    v_pk_fma_f32 v[90:91], v[122:123], v[34:35], v[90:91] op_sel_hi:[1,0,1]
    v_cvt_pk_bf16_f32 v160, v64, v65
    v_cvt_pk_bf16_f32 v161, v66, v67
    v_cvt_pk_bf16_f32 v162, v72, v73
    v_cvt_pk_bf16_f32 v163, v74, v75
    v_cvt_pk_bf16_f32 v164, v80, v81
    v_cvt_pk_bf16_f32 v165, v82, v83
    v_cvt_pk_bf16_f32 v166, v88, v89
    v_cvt_pk_bf16_f32 v167, v90, v91
    s_nop 1
    v_permlane32_swap_b32 v160, v162
    v_permlane32_swap_b32 v161, v163
    v_permlane32_swap_b32 v164, v166
    v_permlane32_swap_b32 v165, v167
    s_nop 1
    v_permlane16_swap_b32 v160, v162
    v_permlane16_swap_b32 v161, v163
    v_permlane16_swap_b32 v164, v166
    v_permlane16_swap_b32 v165, v167
    v_pk_fma_f32 v[68:69], v[100:101], v[46:47], v[68:69] op_sel_hi:[1,0,1]
    v_pk_fma_f32 v[70:71], v[102:103], v[46:47], v[70:71] op_sel_hi:[1,0,1]
    v_pk_fma_f32 v[76:77], v[108:109], v[46:47], v[76:77] op_sel_hi:[1,0,1]
    v_pk_fma_f32 v[78:79], v[110:111], v[46:47], v[78:79] op_sel_hi:[1,0,1]
    v_pk_fma_f32 v[84:85], v[116:117], v[46:47], v[84:85] op_sel_hi:[1,0,1]
    v_pk_fma_f32 v[86:87], v[118:119], v[46:47], v[86:87] op_sel_hi:[1,0,1]
    v_pk_fma_f32 v[92:93], v[124:125], v[46:47], v[92:93] op_sel_hi:[1,0,1]
    v_pk_fma_f32 v[94:95], v[126:127], v[46:47], v[94:95] op_sel_hi:[1,0,1]
    buffer_store_dwordx4 v[160:163], v5, s[24:27], 0 offen offset:0 nt
    buffer_store_dwordx4 v[164:167], v5, s[24:27], 0 offen offset:64 nt
    v_cvt_pk_bf16_f32 v168, v68, v69
    v_cvt_pk_bf16_f32 v169, v70, v71
    v_cvt_pk_bf16_f32 v170, v76, v77
    v_cvt_pk_bf16_f32 v171, v78, v79
    v_cvt_pk_bf16_f32 v172, v84, v85
    v_cvt_pk_bf16_f32 v173, v86, v87
    v_cvt_pk_bf16_f32 v174, v92, v93
    v_cvt_pk_bf16_f32 v175, v94, v95
    s_nop 1
    v_permlane32_swap_b32 v168, v170
    v_permlane32_swap_b32 v169, v171
    v_permlane32_swap_b32 v172, v174
    v_permlane32_swap_b32 v173, v175
    s_nop 1
    v_permlane16_swap_b32 v168, v170
    v_permlane16_swap_b32 v169, v171
    v_permlane16_swap_b32 v172, v174
    v_permlane16_swap_b32 v173, v175
    buffer_store_dwordx4 v[168:171], v6, s[24:27], 0 offen offset:0 nt
    buffer_store_dwordx4 v[172:175], v6, s[24:27], 0 offen offset:64 nt
    s_endpgm
K3_G0T:
    s_waitcnt vmcnt(1)
    s_waitcnt lgkmcnt(6)
    v_mfma_f32_16x16x32_bf16 v[96:99], v[48:51], v[248:251], v[96:99]
    s_waitcnt lgkmcnt(4)
    v_mfma_f32_16x16x32_bf16 v[104:107], v[52:55], v[248:251], v[104:107]
    s_waitcnt lgkmcnt(2)
    v_mfma_f32_16x16x32_bf16 v[112:115], v[56:59], v[248:251], v[112:115]
    s_waitcnt lgkmcnt(0)
    v_mfma_f32_16x16x32_bf16 v[120:123], v[60:63], v[248:251], v[120:123]
    s_waitcnt vmcnt(0)
    v_mfma_f32_16x16x32_bf16 v[100:103], v[48:51], v[252:255], v[100:103]
    v_mfma_f32_16x16x32_bf16 v[108:111], v[52:55], v[252:255], v[108:111]
    v_mfma_f32_16x16x32_bf16 v[116:119], v[56:59], v[252:255], v[116:119]
    v_mfma_f32_16x16x32_bf16 v[124:127], v[60:63], v[252:255], v[124:127]
    s_nop 11
    v_pk_fma_f32 v[64:65], v[96:97], v[34:35], v[64:65] op_sel_hi:[1,0,1]
    v_pk_fma_f32 v[66:67], v[98:99], v[34:35], v[66:67] op_sel_hi:[1,0,1]
    v_pk_fma_f32 v[68:69], v[100:101], v[46:47], v[68:69] op_sel_hi:[1,0,1]
    v_pk_fma_f32 v[70:71], v[102:103], v[46:47], v[70:71] op_sel_hi:[1,0,1]
    v_pk_fma_f32 v[72:73], v[104:105], v[34:35], v[72:73] op_sel_hi:[1,0,1]
    v_pk_fma_f32 v[74:75], v[106:107], v[34:35], v[74:75] op_sel_hi:[1,0,1]
    v_pk_fma_f32 v[76:77], v[108:109], v[46:47], v[76:77] op_sel_hi:[1,0,1]
    v_pk_fma_f32 v[78:79], v[110:111], v[46:47], v[78:79] op_sel_hi:[1,0,1]
    v_pk_fma_f32 v[80:81], v[112:113], v[34:35], v[80:81] op_sel_hi:[1,0,1]
    v_pk_fma_f32 v[82:83], v[114:115], v[34:35], v[82:83] op_sel_hi:[1,0,1]
    v_pk_fma_f32 v[84:85], v[116:117], v[46:47], v[84:85] op_sel_hi:[1,0,1]
    v_pk_fma_f32 v[86:87], v[118:119], v[46:47], v[86:87] op_sel_hi:[1,0,1]
    v_pk_fma_f32 v[88:89], v[120:121], v[34:35], v[88:89] op_sel_hi:[1,0,1]
    v_pk_fma_f32 v[90:91], v[122:123], v[34:35], v[90:91] op_sel_hi:[1,0,1]
    v_pk_fma_f32 v[92:93], v[124:125], v[46:47], v[92:93] op_sel_hi:[1,0,1]
    v_pk_fma_f32 v[94:95], v[126:127], v[46:47], v[94:95] op_sel_hi:[1,0,1]
    ds_write_b128 v4, v[64:67] offset:0
    ds_write_b128 v4, v[68:71] offset:1024
    ds_write_b128 v4, v[72:75] offset:2048
    ds_write_b128 v4, v[76:79] offset:3072
    ds_write_b128 v4, v[80:83] offset:4096
    ds_write_b128 v4, v[84:87] offset:5120
    ds_write_b128 v4, v[88:91] offset:6144
    ds_write_b128 v4, v[92:95] offset:7168
    s_waitcnt lgkmcnt(0)
    s_barrier
    s_endpgm
K2_FB:
    s_mov_b32 s60, 17
    s_mov_b32 s61, 0
    v_mov_b32 v96, 0
    v_mov_b32 v97, 0
    v_mov_b32 v98, 0
    v_mov_b32 v99, 0
    v_mov_b32 v100, 0
    v_mov_b32 v101, 0
    v_mov_b32 v102, 0
    v_mov_b32 v103, 0
    v_mov_b32 v104, 0
    v_mov_b32 v105, 0
    v_mov_b32 v106, 0
    v_mov_b32 v107, 0
    v_mov_b32 v108, 0
    v_mov_b32 v109, 0
    v_mov_b32 v110, 0
    v_mov_b32 v111, 0
    v_mov_b32 v112, 0
    v_mov_b32 v113, 0
    v_mov_b32 v114, 0
    v_mov_b32 v115, 0
    v_mov_b32 v44, 0xff800000
K2_FBL:
    buffer_load_dwordx4 v[16:19], v3, s[32:35], s70 offen sc1
    buffer_load_dwordx4 v[20:23], v3, s[32:35], s70 offen offset:1024 sc1
    buffer_load_dwordx4 v[24:27], v3, s[32:35], s70 offen offset:2048 sc1
    buffer_load_dwordx4 v[28:31], v3, s[32:35], s70 offen offset:3072 sc1
    s_add_u32 s70, s70, 4096
    s_waitcnt vmcnt(0)
    v_mfma_f32_32x32x16_bf16 v[64:79], v[16:19], v[8:11], 0
    v_mfma_f32_32x32x16_bf16 v[64:79], v[20:23], v[12:15], v[64:79]
    s_nop 11
    v_max3_f32 v4, v64, v65, v66
    v_max3_f32 v4, v4, v67, v68
    v_max3_f32 v4, v4, v69, v70
    v_max3_f32 v4, v4, v71, v72
    v_max3_f32 v4, v4, v73, v74
    v_max3_f32 v4, v4, v75, v76
    v_max3_f32 v4, v4, v77, v78
    v_max3_f32 v4, v4, v79, v44
    v_mov_b32 v5, v4
    s_nop 1
    v_permlane32_swap_b32 v4, v5
    s_nop 0
    v_max_f32 v4, v4, v5
    v_sub_f32 v5, v44, v4
    v_exp_f32 v5, v5
    v_mov_b32 v44, v4
    v_sub_f32 v64, v64, v4
    v_sub_f32 v65, v65, v4
    v_sub_f32 v66, v66, v4
    v_sub_f32 v67, v67, v4
    v_sub_f32 v68, v68, v4
    v_sub_f32 v69, v69, v4
    v_sub_f32 v70, v70, v4
    v_sub_f32 v71, v71, v4
    v_sub_f32 v72, v72, v4
    v_sub_f32 v73, v73, v4
    v_sub_f32 v74, v74, v4
    v_sub_f32 v75, v75, v4
    v_sub_f32 v76, v76, v4
    v_sub_f32 v77, v77, v4
    v_sub_f32 v78, v78, v4
    v_sub_f32 v79, v79, v4
    v_exp_f32 v64, v64
    v_exp_f32 v65, v65
    v_exp_f32 v66, v66
    v_exp_f32 v67, v67
    v_exp_f32 v68, v68
    v_exp_f32 v69, v69
    v_exp_f32 v70, v70
    v_exp_f32 v71, v71
    v_exp_f32 v72, v72
    v_exp_f32 v73, v73
    v_exp_f32 v74, v74
    v_exp_f32 v75, v75
    v_exp_f32 v76, v76
    v_exp_f32 v77, v77
    v_exp_f32 v78, v78
    v_exp_f32 v79, v79
    v_mul_f32 v96, v96, v5
    v_mul_f32 v97, v97, v5
    v_mul_f32 v98, v98, v5
    v_mul_f32 v99, v99, v5
    v_mul_f32 v100, v100, v5
    v_mul_f32 v101, v101, v5
    v_mul_f32 v102, v102, v5
    v_mul_f32 v103, v103, v5
    v_mul_f32 v104, v104, v5
    v_mul_f32 v105, v105, v5
    v_mul_f32 v106, v106, v5
    v_mul_f32 v107, v107, v5
    v_mul_f32 v108, v108, v5
    v_mul_f32 v109, v109, v5
    v_mul_f32 v110, v110, v5
    v_mul_f32 v111, v111, v5
    v_mul_f32 v112, v112, v5
    v_mul_f32 v113, v113, v5
    v_mul_f32 v114, v114, v5
    v_mul_f32 v115, v115, v5
    v_cvt_pk_bf16_f32 v120, v64, v65
    v_cvt_pk_bf16_f32 v121, v66, v67
    v_cvt_pk_bf16_f32 v122, v68, v69
    v_cvt_pk_bf16_f32 v123, v70, v71
    v_cvt_pk_bf16_f32 v124, v72, v73
    v_cvt_pk_bf16_f32 v125, v74, v75
    v_cvt_pk_bf16_f32 v126, v76, v77
    v_cvt_pk_bf16_f32 v127, v78, v79
    s_nop 1
    v_mfma_f32_32x32x16_bf16 v[96:111], v[24:27], v[120:123], v[96:111]
    v_mfma_f32_16x16x32_bf16 v[112:115], v[40:43], v[120:123], v[112:115]
    v_mfma_f32_32x32x16_bf16 v[96:111], v[28:31], v[124:127], v[96:111]
    v_mfma_f32_16x16x32_bf16 v[112:115], v[40:43], v[124:127], v[112:115]
    s_add_u32 s61, s61, 1
    s_cmp_lt_u32 s61, 64
    s_nop 11
    s_cbranch_scc1 K2_FBL
    s_branch K2_FIN
KF_END:
    s_endpgm
.section .rodata,"a"
.p2align 6
.amdhsa_kernel gated_mix__linear_kernel_hedgehog__softmax_full_mha__prompt_kernel
  .amdhsa_next_free_vgpr 256
  .amdhsa_next_free_sgpr 102
  .amdhsa_accum_offset 256
  .amdhsa_group_segment_fixed_size 0
  .amdhsa_kernarg_size 88
  .amdhsa_user_sgpr_count 2
  .amdhsa_user_sgpr_kernarg_segment_ptr 1
  .amdhsa_system_sgpr_workgroup_id_x 1
.end_amdhsa_kernel
```
